```python
import torch

def _softmax(x, axis=-1):
    return torch.softmax(x, dim=axis)
def _gelu(x):
    return torch.nn.functional.gelu(x, approximate="tanh")
def _silu(x):
    return torch.nn.functional.silu(x)
def _sigmoid(x):
    return torch.sigmoid(x)
def _layernorm(x, axis=-1, eps=1e-5):
    m = x.mean(dim=axis, keepdim=True)
    v = x.var(dim=axis, keepdim=True, unbiased=False)
    return (x - m) / torch.sqrt(v + eps)
def _scatter_add(tgt, idx, src, axis=0):
    return tgt.clone().index_add_(axis, idx, src)
def _segment_sum(src, seg, n):
    out = torch.zeros((n,) + src.shape[1:], dtype=src.dtype)
    return out.index_add_(0, seg, src)
def _pad(x, pw):
    flat = tuple(v for pair in reversed(pw) for v in pair)
    return torch.nn.functional.pad(x, flat)

kernel_name = 'recurrent_scan__sliding_block_cached__glu_gated_bilinear__decode'

def setup_inputs():

    _w = (lambda a: (lambda t: t.to(torch.bfloat16) if t.is_floating_point() else t)(torch.as_tensor(a)))
    def _A_setup():
        B, Sq, D = 2, 1, 448
        Hq, Hkv, Sk, Dh = 16, 8, 32768, 256
        assert Hq % Hkv == 0, (Hq, Hkv)
        return {
            "x": _w((lambda *s: torch.randn(*s, dtype=torch.bfloat16) * 0.2)(B, Sq, D)),
            "k_cache": _w((lambda *s: torch.randn(*s, dtype=torch.bfloat16) * 1.6)(B, Hkv, Sk, Dh)),
            "v_cache": _w((lambda *s: torch.randn(*s, dtype=torch.bfloat16) * 1.6)(B, Hkv, Sk, Dh)),
            "wq": _w((lambda *s: torch.randn(*s, dtype=torch.bfloat16) * 1.6)(D, Hq * Dh) * (D ** -0.5)),
            "wo": _w((lambda *s: torch.randn(*s, dtype=torch.bfloat16) * 1.6)(Hq * Dh, D) * ((Hq * Dh) ** -0.5)),
        }
    _A_in = _A_setup()

    def _B_setup():
        B, S, D, F = 2, 1, 448, 1792
        return {
            "x": _w((lambda *s: torch.randn(*s, dtype=torch.bfloat16) * 0.2)(B, S, D)),
            "w_gate": _w((lambda *s: torch.randn(*s, dtype=torch.bfloat16) * 0.8)(D, F) * (D ** -0.5)),
            "w_up": _w((lambda *s: torch.randn(*s, dtype=torch.bfloat16) * 0.8)(D, F) * (D ** -0.5)),
            "w_down": _w((lambda *s: torch.randn(*s, dtype=torch.bfloat16) * 0.8)(F, D) * (F ** -0.5)),
        }
    _B_in = _B_setup()

    return {
        "A_x": _A_in["x"],
        "A_k_cache": _A_in["k_cache"],
        "A_v_cache": _A_in["v_cache"],
        "A_wq": _A_in["wq"],
        "A_wo": _A_in["wo"],
        "B_x": _B_in["x"],
        "B_w_gate": _B_in["w_gate"],
        "B_w_up": _B_in["w_up"],
        "B_w_down": _B_in["w_down"],
    }

def reference(A_x, A_k_cache, A_v_cache, A_wq, A_wo, B_x, B_w_gate, B_w_up, B_w_down):
    def _A_ref(x, k_cache, v_cache, wq, wo):
        B, Sq, D = x.shape
        Hq, Dh = 16, 256
        Hkv, Sk = k_cache.shape[1], k_cache.shape[2]
        W = min(4096, max(256, Sk // 4))
        rep = Hq // Hkv
        q = (lambda x, *d: x.permute(*d))((x @ wq).reshape(B, Sq, Hq, Dh), 0, 2, 1, 3)
        k = (lambda x, n, axis: torch.repeat_interleave(x, n, dim=axis))(k_cache[:, :, Sk - W:, :], rep, axis=1)
        v = (lambda x, n, axis: torch.repeat_interleave(x, n, dim=axis))(v_cache[:, :, Sk - W:, :], rep, axis=1)
        scores = torch.einsum("bhqd,bhkd->bhqk", q, k) * (Dh ** -0.5)
        p = _softmax(scores, axis=-1)
        o = torch.einsum("bhqk,bhkd->bhqd", p, v)
        return (lambda x, *d: x.permute(*d))(o, 0, 2, 1, 3).reshape(B, Sq, Hq * Dh) @ wo

    def _B_ref(x, w_gate, w_up, w_down):
        g = torch.einsum("bsd,df->bsf", x, w_gate)
        u = torch.einsum("bsd,df->bsf", x, w_up)
        h = g * u
        return torch.einsum("bsf,fd->bsd", h, w_down)

    x = A_x
    xn = _layernorm(x, axis=-1)
    s = _A_ref(xn, A_k_cache, A_v_cache, A_wq, A_wo)
    g = _silu(_B_ref(xn, B_w_gate, B_w_up, B_w_down))
    return x + s * g
```

```asm
; @launch grid=(256,1,1) block=(512,1,1) lds=136192
.amdgcn_target "amdgcn-amd-amdhsa--gfx950"
.text
.globl recurrent_scan__sliding_block_cached__glu_gated_bilinear__decode_kernel
.p2align 8
.type recurrent_scan__sliding_block_cached__glu_gated_bilinear__decode_kernel,@function
recurrent_scan__sliding_block_cached__glu_gated_bilinear__decode_kernel:
    s_cmp_ge_u32 s2, 256
    s_cbranch_scc1 L_end
    s_load_dwordx16 s[4:19], s[0:1], 0
    s_load_dwordx8 s[20:27], s[0:1], 64
    s_getpc_b64 s[46:47]
L_pc0:
    v_lshlrev_b32 v250, 6, v0
    v_min_u32 v250, L_end-L_pc0, v250
    global_load_dword v251, v250, s[46:47]
    v_lshrrev_b32 v1, 6, v0
    v_and_b32 v0, 63, v0
    s_and_b32 s29, s2, 7
    v_readfirstlane_b32 s28, v1
    s_lshr_b32 s30, s2, 3
    s_lshr_b32 s31, s30, 4
    s_and_b32 s32, s30, 15
    s_mov_b32 s33, 0x05040100
    s_mov_b32 s34, 0x07060302
    v_mov_b32 v1, 0x20000
    v_mov_b32 v2, 1
    v_lshl_add_u32 v3, v0, 2, v1
    v_mov_b32 v4, 0
    ds_write_b32 v3, v4
    s_cmp_ge_u32 s28, 4
    s_cbranch_scc1 L_service
    v_lshrrev_b32 v3, 5, v0
    v_and_b32 v4, 31, v0
    s_lshl_b32 s36, s28, 2
    v_add_u32 v5, s36, v3
    v_xor_b32 v11, v4, v5
    v_lshlrev_b32 v11, 4, v11
    v_lshl_add_u32 v6, v5, 9, v11
    v_add_u32 v12, 2, v5
    v_xor_b32 v11, v4, v12
    v_lshlrev_b32 v11, 4, v11
    v_lshl_add_u32 v7, v5, 9, v11
    v_lshrrev_b32 v11, 3, v0
    v_and_b32 v12, 7, v0
    v_lshlrev_b32 v12, 4, v12
    v_lshl_add_u32 v8, v11, 9, v12
    s_lshl_b32 s36, s28, 7
    v_add_u32 v8, s36, v8
    v_add_u32 v250, 4096, v8
    v_lshrrev_b32 v11, 3, v0
    v_and_b32 v12, 7, v0
    v_lshlrev_b32 v12, 4, v12
    s_lshr_b32 s36, s30, 3
    s_mul_i32 s36, s36, 112
    v_add_u32 v9, s36, v11
    v_lshl_add_u32 v9, v9, 13, v12
    s_and_b32 s37, s30, 7
    s_lshl_b32 s37, s37, 7
    s_lshl_b32 s38, s29, 10
    s_add_u32 s37, s37, s38
    v_add_u32 v9, s37, v9
    s_and_b32 s36, s30, 3
    s_mul_i32 s36, s36, 112
    v_add_u32 v10, s36, v11
    v_mul_u32_u24 v10, 3584, v10
    s_lshr_b32 s37, s30, 3
    s_lshl_b32 s38, s29, 2
    s_add_u32 s37, s37, s38
    s_lshl_b32 s37, s37, 7
    v_add3_u32 v10, v10, v12, s37
    s_lshl_b32 s37, s31, 3
    s_add_u32 s37, s37, s29
    s_lshl_b32 s37, s37, 24
    s_add_u32 s37, s37, 14680064
    s_lshl_b32 s64, s28, 11
    s_waitcnt lgkmcnt(0)
    s_mov_b32 s56, s10
    s_mov_b32 s57, s11
    s_mov_b32 s58, 3670016
    s_mov_b32 s59, 0x00020000
    s_getreg_b32 s40, hwreg(HW_REG_XCC_ID, 0, 1)
    s_mov_b32 s41, 0
    s_mov_b64 vcc, s[40:41]
    s_getreg_b32 s78, hwreg(HW_REG_XCC_ID, 2, 1)
    s_bitcmp1_b32 s30, 2
    s_cselect_b32 s60, s18, s16
    s_cselect_b32 s61, s19, s17
    s_mov_b32 s62, 1605632
    s_mov_b32 s63, 0x00020000
    s_lshl_b32 s65, s28, 16
    s_lshl_b32 s66, s28, 10
    s_add_u32 s66, s66, 98304
    s_add_u32 m0, s66, 0
    s_add_u32 s36, s65, 0
    buffer_load_dwordx4 v9, s[56:59], s36 offen nt lds
    s_add_u32 m0, s66, 4096
    s_add_u32 s36, s65, 262144
    buffer_load_dwordx4 v9, s[56:59], s36 offen nt lds
    s_add_u32 m0, s66, 8192
    s_add_u32 s36, s65, 524288
    buffer_load_dwordx4 v9, s[56:59], s36 offen nt lds
    s_cmp_ge_u32 s28, 2
    s_cbranch_scc1 L_sq3
    s_add_u32 m0, s66, 12288
    s_add_u32 s36, s65, 786432
    buffer_load_dwordx4 v9, s[56:59], s36 offen nt lds
L_sq3:
    s_add_u32 s48, s6, s37
    s_addc_u32 s49, s7, 0
    s_mov_b32 s50, 2097152
    s_mov_b32 s51, 0x00020000
    s_add_u32 s52, s8, s37
    s_addc_u32 s53, s9, 0
    s_mov_b32 s54, 2097152
    s_mov_b32 s55, 0x00020000
    s_cmp_eq_u32 s29, 7
    s_cbranch_scc1 L_sg3
    s_sub_u32 s38, 3, s28
    s_mul_i32 s65, s38, 28672
    s_lshl_b32 s66, s38, 10
    s_add_u32 s66, s66, 112640
    s_add_u32 m0, s66, 0
    s_add_u32 s36, s65, 0
    buffer_load_dwordx4 v10, s[60:63], s36 offen nt lds
    s_add_u32 m0, s66, 4096
    s_add_u32 s36, s65, 114688
    buffer_load_dwordx4 v10, s[60:63], s36 offen nt lds
    s_add_u32 m0, s66, 8192
    s_add_u32 s36, s65, 229376
    buffer_load_dwordx4 v10, s[60:63], s36 offen nt lds
    s_cmp_lt_u32 s28, 2
    s_cbranch_scc1 L_sg3
    s_add_u32 m0, s66, 12288
    s_add_u32 s36, s65, 344064
    buffer_load_dwordx4 v10, s[60:63], s36 offen nt lds
L_sg3:
    s_barrier
    s_add_u32 m0, s64, 0
    s_add_u32 s36, s32, 0
    s_and_b32 s36, s36, 15
    s_lshl_b32 s36, s36, 13
    s_add_u32 s36, s36, 0
    buffer_load_dwordx4 v6, s[48:51], s36 offen nt lds
    s_cbranch_vccnz L_wd1
    s_waitcnt vmcnt(6)
L_wd1:
    s_waitcnt vmcnt(7)
    buffer_load_dwordx4 v7, s[48:51], s36 offen offset:1024 nt lds
    s_cbranch_vccnz L_wd2
    s_waitcnt vmcnt(6)
L_wd2:
    s_waitcnt vmcnt(7)
    s_add_u32 m0, s64, 8192
    s_add_u32 s36, s32, 1
    s_and_b32 s36, s36, 15
    s_lshl_b32 s36, s36, 13
    s_add_u32 s36, s36, 131072
    buffer_load_dwordx4 v6, s[48:51], s36 offen nt lds
    s_cbranch_vccnz L_wd3
    s_waitcnt vmcnt(6)
L_wd3:
    s_waitcnt vmcnt(7)
    buffer_load_dwordx4 v7, s[48:51], s36 offen offset:1024 nt lds
    s_cbranch_vccnz L_wd4
    s_waitcnt vmcnt(6)
L_wd4:
    s_waitcnt vmcnt(7)
    s_add_u32 m0, s64, 16384
    s_add_u32 s36, s32, 2
    s_and_b32 s36, s36, 15
    s_lshl_b32 s36, s36, 13
    s_add_u32 s36, s36, 262144
    buffer_load_dwordx4 v6, s[48:51], s36 offen nt lds
    s_cbranch_vccnz L_wd5
    s_waitcnt vmcnt(6)
L_wd5:
    s_waitcnt vmcnt(7)
    buffer_load_dwordx4 v7, s[48:51], s36 offen offset:1024 nt lds
    s_cbranch_vccnz L_wd6
    s_waitcnt vmcnt(6)
L_wd6:
    s_waitcnt vmcnt(7)
    s_add_u32 m0, s64, 24576
    s_add_u32 s36, s32, 3
    s_and_b32 s36, s36, 15
    s_lshl_b32 s36, s36, 13
    s_add_u32 s36, s36, 393216
    buffer_load_dwordx4 v6, s[48:51], s36 offen nt lds
    s_cbranch_vccnz L_wd7
    s_waitcnt vmcnt(6)
L_wd7:
    s_waitcnt vmcnt(7)
    s_mov_b64 s[80:81], exec
    s_mov_b64 exec, 1
    ds_add_u32 v1, v2 offset:100
    s_mov_b64 exec, s[80:81]
    buffer_load_dwordx4 v7, s[48:51], s36 offen offset:1024 nt lds
    s_cbranch_vccnz L_wd8
    s_waitcnt vmcnt(6)
L_wd8:
    s_waitcnt vmcnt(7)
    s_add_u32 m0, s64, 32768
    s_add_u32 s36, s32, 4
    s_and_b32 s36, s36, 15
    s_lshl_b32 s36, s36, 13
    s_add_u32 s36, s36, 524288
    buffer_load_dwordx4 v6, s[48:51], s36 offen nt lds
    s_cbranch_vccnz L_wd9
    s_waitcnt vmcnt(6)
L_wd9:
    s_waitcnt vmcnt(7)
    buffer_load_dwordx4 v7, s[48:51], s36 offen offset:1024 nt lds
    s_cbranch_vccnz L_wd10
    s_waitcnt vmcnt(6)
L_wd10:
    s_waitcnt vmcnt(7)
    s_add_u32 m0, s64, 40960
    s_add_u32 s36, s32, 5
    s_and_b32 s36, s36, 15
    s_lshl_b32 s36, s36, 13
    s_add_u32 s36, s36, 655360
    buffer_load_dwordx4 v6, s[48:51], s36 offen nt lds
    s_cbranch_vccnz L_wd11
    s_waitcnt vmcnt(6)
L_wd11:
    s_waitcnt vmcnt(7)
    buffer_load_dwordx4 v7, s[48:51], s36 offen offset:1024 nt lds
    s_cbranch_vccnz L_wd12
    s_waitcnt vmcnt(6)
L_wd12:
    s_waitcnt vmcnt(7)
    s_add_u32 m0, s64, 49152
    s_add_u32 s36, s32, 6
    s_and_b32 s36, s36, 15
    s_lshl_b32 s36, s36, 13
    s_add_u32 s36, s36, 786432
    buffer_load_dwordx4 v6, s[48:51], s36 offen nt lds
    s_cbranch_vccnz L_wd13
    s_waitcnt vmcnt(6)
L_wd13:
    s_waitcnt vmcnt(7)
    buffer_load_dwordx4 v7, s[48:51], s36 offen offset:1024 nt lds
    s_cbranch_vccnz L_wd14
    s_waitcnt vmcnt(6)
L_wd14:
    s_waitcnt vmcnt(7)
    s_add_u32 m0, s64, 57344
    s_add_u32 s36, s32, 7
    s_and_b32 s36, s36, 15
    s_lshl_b32 s36, s36, 13
    s_add_u32 s36, s36, 917504
    buffer_load_dwordx4 v6, s[48:51], s36 offen nt lds
    s_cbranch_vccnz L_wd15
    s_waitcnt vmcnt(6)
L_wd15:
    s_waitcnt vmcnt(7)
    buffer_load_dwordx4 v7, s[48:51], s36 offen offset:1024 nt lds
    s_cbranch_vccnz L_wd16
    s_waitcnt vmcnt(6)
L_wd16:
    s_waitcnt vmcnt(7)
    s_add_u32 m0, s64, 65536
    s_add_u32 s36, s32, 8
    s_and_b32 s36, s36, 15
    s_lshl_b32 s36, s36, 13
    s_add_u32 s36, s36, 1048576
    buffer_load_dwordx4 v6, s[48:51], s36 offen nt lds
    s_cbranch_vccnz L_wd17
    s_waitcnt vmcnt(6)
L_wd17:
    s_waitcnt vmcnt(7)
    buffer_load_dwordx4 v7, s[48:51], s36 offen offset:1024 nt lds
    s_cbranch_vccnz L_wd18
    s_waitcnt vmcnt(6)
L_wd18:
    s_waitcnt vmcnt(7)
    s_add_u32 m0, s64, 73728
    s_add_u32 s36, s32, 9
    s_and_b32 s36, s36, 15
    s_lshl_b32 s36, s36, 13
    s_add_u32 s36, s36, 1179648
    buffer_load_dwordx4 v6, s[48:51], s36 offen nt lds
    s_cbranch_vccnz L_wd19
    s_waitcnt vmcnt(6)
L_wd19:
    s_waitcnt vmcnt(7)
    buffer_load_dwordx4 v7, s[48:51], s36 offen offset:1024 nt lds
    s_cbranch_vccnz L_wd20
    s_waitcnt vmcnt(6)
L_wd20:
    s_waitcnt vmcnt(7)
    s_add_u32 m0, s64, 81920
    s_add_u32 s36, s32, 10
    s_and_b32 s36, s36, 15
    s_lshl_b32 s36, s36, 13
    s_add_u32 s36, s36, 1310720
    buffer_load_dwordx4 v6, s[48:51], s36 offen nt lds
    s_cbranch_vccnz L_wd21
    s_waitcnt vmcnt(6)
L_wd21:
    s_waitcnt vmcnt(7)
    buffer_load_dwordx4 v7, s[48:51], s36 offen offset:1024 nt lds
    s_cbranch_vccnz L_wd22
    s_waitcnt vmcnt(6)
L_wd22:
    s_waitcnt vmcnt(7)
    s_add_u32 m0, s64, 90112
    s_add_u32 s36, s32, 11
    s_and_b32 s36, s36, 15
    s_lshl_b32 s36, s36, 13
    s_add_u32 s36, s36, 1441792
    buffer_load_dwordx4 v6, s[48:51], s36 offen nt lds
    s_cbranch_vccnz L_wd23
    s_waitcnt vmcnt(6)
L_wd23:
    s_waitcnt vmcnt(7)
    buffer_load_dwordx4 v7, s[48:51], s36 offen offset:1024 nt lds
    s_cbranch_vccnz L_wd24
    s_waitcnt vmcnt(6)
L_wd24:
    s_waitcnt vmcnt(7)
    s_mov_b32 s46, 0
L_lw1:
    ds_read_b32 v11, v1 offset:104
    s_add_u32 s46, s46, 1
    s_waitcnt lgkmcnt(0)
    v_readfirstlane_b32 s47, v11
    s_nop 0
    s_cmp_ge_u32 s47, 2
    s_cbranch_scc1 L_lw1_d
    s_sleep 1
    s_cmp_lt_u32 s46, 0x400000
    s_cbranch_scc1 L_lw1
L_lw1_d:
    s_add_u32 m0, s64, 98304
    s_add_u32 s36, s32, 12
    s_and_b32 s36, s36, 15
    s_lshl_b32 s36, s36, 13
    s_add_u32 s36, s36, 1572864
    buffer_load_dwordx4 v6, s[48:51], s36 offen nt lds
    s_cbranch_vccnz L_wd25
    s_waitcnt vmcnt(6)
L_wd25:
    s_waitcnt vmcnt(7)
    buffer_load_dwordx4 v7, s[48:51], s36 offen offset:1024 nt lds
    s_cbranch_vccnz L_wd26
    s_waitcnt vmcnt(6)
L_wd26:
    s_waitcnt vmcnt(7)
    s_add_u32 m0, s64, 106496
    s_add_u32 s36, s32, 13
    s_and_b32 s36, s36, 15
    s_lshl_b32 s36, s36, 13
    s_add_u32 s36, s36, 1703936
    buffer_load_dwordx4 v6, s[48:51], s36 offen nt lds
    s_cbranch_vccnz L_wd27
    s_waitcnt vmcnt(6)
L_wd27:
    s_waitcnt vmcnt(7)
    buffer_load_dwordx4 v7, s[48:51], s36 offen offset:1024 nt lds
    s_cbranch_vccnz L_wd28
    s_waitcnt vmcnt(6)
L_wd28:
    s_waitcnt vmcnt(7)
    s_add_u32 m0, s64, 114688
    s_add_u32 s36, s32, 14
    s_and_b32 s36, s36, 15
    s_lshl_b32 s36, s36, 13
    s_add_u32 s36, s36, 1835008
    buffer_load_dwordx4 v6, s[48:51], s36 offen nt lds
    s_cbranch_vccnz L_wd29
    s_waitcnt vmcnt(6)
L_wd29:
    s_waitcnt vmcnt(7)
    buffer_load_dwordx4 v7, s[48:51], s36 offen offset:1024 nt lds
    s_cbranch_vccnz L_wd30
    s_waitcnt vmcnt(6)
L_wd30:
    s_waitcnt vmcnt(7)
    s_add_u32 m0, s64, 122880
    s_add_u32 s36, s32, 15
    s_and_b32 s36, s36, 15
    s_lshl_b32 s36, s36, 13
    s_add_u32 s36, s36, 1966080
    buffer_load_dwordx4 v6, s[48:51], s36 offen nt lds
    s_cbranch_vccnz L_wd31
    s_waitcnt vmcnt(6)
L_wd31:
    s_waitcnt vmcnt(7)
    buffer_load_dwordx4 v7, s[48:51], s36 offen offset:1024 nt lds
    s_cbranch_vccnz L_wd32
    s_waitcnt vmcnt(6)
L_wd32:
    s_waitcnt vmcnt(7)
    s_add_u32 s36, s32, 0
    s_and_b32 s36, s36, 15
    s_lshl_b32 s36, s36, 13
    s_add_u32 s36, s36, 0
    buffer_load_dwordx4 v[96:99], v8, s[52:55], s36 offen nt
    s_cbranch_vccnz L_wd33
    s_waitcnt vmcnt(6)
L_wd33:
    s_waitcnt vmcnt(7)
    buffer_load_dwordx4 v[100:103], v250, s[52:55], s36 offen nt
    s_cbranch_vccnz L_wd34
    s_waitcnt vmcnt(6)
L_wd34:
    s_waitcnt vmcnt(7)
    s_add_u32 s36, s32, 1
    s_and_b32 s36, s36, 15
    s_lshl_b32 s36, s36, 13
    s_add_u32 s36, s36, 131072
    buffer_load_dwordx4 v[104:107], v8, s[52:55], s36 offen nt
    s_cbranch_vccnz L_wd35
    s_waitcnt vmcnt(6)
L_wd35:
    s_waitcnt vmcnt(7)
    buffer_load_dwordx4 v[108:111], v250, s[52:55], s36 offen nt
    s_cbranch_vccnz L_wd36
    s_waitcnt vmcnt(6)
L_wd36:
    s_waitcnt vmcnt(7)
    s_add_u32 s36, s32, 2
    s_and_b32 s36, s36, 15
    s_lshl_b32 s36, s36, 13
    s_add_u32 s36, s36, 262144
    buffer_load_dwordx4 v[112:115], v8, s[52:55], s36 offen nt
    s_cbranch_vccnz L_wd37
    s_waitcnt vmcnt(6)
L_wd37:
    s_waitcnt vmcnt(7)
    buffer_load_dwordx4 v[116:119], v250, s[52:55], s36 offen nt
    s_cbranch_vccnz L_wd38
    s_waitcnt vmcnt(6)
L_wd38:
    s_waitcnt vmcnt(7)
    s_add_u32 s36, s32, 3
    s_and_b32 s36, s36, 15
    s_lshl_b32 s36, s36, 13
    s_add_u32 s36, s36, 393216
    buffer_load_dwordx4 v[120:123], v8, s[52:55], s36 offen nt
    s_cbranch_vccnz L_wd39
    s_waitcnt vmcnt(6)
L_wd39:
    s_waitcnt vmcnt(7)
    s_mov_b64 s[80:81], exec
    s_mov_b64 exec, 1
    ds_add_u32 v1, v2 offset:64
    s_mov_b64 exec, s[80:81]
    buffer_load_dwordx4 v[124:127], v250, s[52:55], s36 offen nt
    s_cbranch_vccnz L_wd40
    s_waitcnt vmcnt(6)
L_wd40:
    s_waitcnt vmcnt(7)
    s_cmp_lg_u32 s28, 0
    s_cbranch_scc1 L_tk0
    s_mov_b32 s46, 0
L_lw2:
    ds_read_b32 v11, v1 offset:88
    s_add_u32 s46, s46, 1
    s_waitcnt lgkmcnt(0)
    v_readfirstlane_b32 s47, v11
    s_nop 0
    s_cmp_ge_u32 s47, 1
    s_cbranch_scc1 L_lw2_d
    s_sleep 1
    s_cmp_lt_u32 s46, 0x400000
    s_cbranch_scc1 L_lw2
L_lw2_d:
    s_lshl_b32 s37, s29, 7
    s_add_u32 s37, s37, 1204224
    v_mov_b32 v11, s37
    s_mov_b64 exec, 1
    global_atomic_add v12, v11, v2, s[26:27] sc0 sc1
    s_mov_b64 exec, -1
L_tk0:
    s_add_u32 s36, s32, 4
    s_and_b32 s36, s36, 15
    s_lshl_b32 s36, s36, 13
    s_add_u32 s36, s36, 524288
    buffer_load_dwordx4 v[128:131], v8, s[52:55], s36 offen nt
    s_cbranch_vccnz L_wd41
    s_waitcnt vmcnt(6)
L_wd41:
    s_waitcnt vmcnt(7)
    buffer_load_dwordx4 v[132:135], v250, s[52:55], s36 offen nt
    s_cbranch_vccnz L_wd42
    s_waitcnt vmcnt(6)
L_wd42:
    s_waitcnt vmcnt(7)
    s_add_u32 s36, s32, 5
    s_and_b32 s36, s36, 15
    s_lshl_b32 s36, s36, 13
    s_add_u32 s36, s36, 655360
    buffer_load_dwordx4 v[136:139], v8, s[52:55], s36 offen nt
    s_cbranch_vccnz L_wd43
    s_waitcnt vmcnt(6)
L_wd43:
    s_waitcnt vmcnt(7)
    buffer_load_dwordx4 v[140:143], v250, s[52:55], s36 offen nt
    s_cbranch_vccnz L_wd44
    s_waitcnt vmcnt(6)
L_wd44:
    s_waitcnt vmcnt(7)
    s_add_u32 s36, s32, 6
    s_and_b32 s36, s36, 15
    s_lshl_b32 s36, s36, 13
    s_add_u32 s36, s36, 786432
    buffer_load_dwordx4 v[144:147], v8, s[52:55], s36 offen nt
    s_cbranch_vccnz L_wd45
    s_waitcnt vmcnt(6)
L_wd45:
    s_waitcnt vmcnt(7)
    buffer_load_dwordx4 v[148:151], v250, s[52:55], s36 offen nt
    s_cbranch_vccnz L_wd46
    s_waitcnt vmcnt(6)
L_wd46:
    s_waitcnt vmcnt(7)
    s_add_u32 s36, s32, 7
    s_and_b32 s36, s36, 15
    s_lshl_b32 s36, s36, 13
    s_add_u32 s36, s36, 917504
    buffer_load_dwordx4 v[152:155], v8, s[52:55], s36 offen nt
    s_cbranch_vccnz L_wd47
    s_waitcnt vmcnt(6)
L_wd47:
    s_waitcnt vmcnt(7)
    buffer_load_dwordx4 v[156:159], v250, s[52:55], s36 offen nt
    s_cbranch_vccnz L_wd48
    s_waitcnt vmcnt(6)
L_wd48:
    s_waitcnt vmcnt(7)
    s_cmp_lg_u32 s28, 0
    s_cbranch_scc1 L_tk1
    s_mov_b64 exec, 1
    v_add_u32 v12, 1, v12
    ds_write_b32 v1, v12 offset:224
    s_mov_b64 exec, -1
L_tk1:
    s_add_u32 s36, s32, 8
    s_and_b32 s36, s36, 15
    s_lshl_b32 s36, s36, 13
    s_add_u32 s36, s36, 1048576
    buffer_load_dwordx4 v[160:163], v8, s[52:55], s36 offen nt
    s_cbranch_vccnz L_wd49
    s_waitcnt vmcnt(11)
L_wd49:
    s_waitcnt vmcnt(12)
    buffer_load_dwordx4 v[164:167], v250, s[52:55], s36 offen nt
    s_cbranch_vccnz L_wd50
    s_waitcnt vmcnt(11)
L_wd50:
    s_waitcnt vmcnt(12)
    s_add_u32 s36, s32, 9
    s_and_b32 s36, s36, 15
    s_lshl_b32 s36, s36, 13
    s_add_u32 s36, s36, 1179648
    buffer_load_dwordx4 v[168:171], v8, s[52:55], s36 offen nt
    s_cbranch_vccnz L_wd51
    s_waitcnt vmcnt(11)
L_wd51:
    s_waitcnt vmcnt(12)
    buffer_load_dwordx4 v[172:175], v250, s[52:55], s36 offen nt
    s_cbranch_vccnz L_wd52
    s_waitcnt vmcnt(11)
L_wd52:
    s_waitcnt vmcnt(12)
    s_add_u32 s36, s32, 10
    s_and_b32 s36, s36, 15
    s_lshl_b32 s36, s36, 13
    s_add_u32 s36, s36, 1310720
    buffer_load_dwordx4 v[176:179], v8, s[52:55], s36 offen nt
    s_cbranch_vccnz L_wd53
    s_waitcnt vmcnt(11)
L_wd53:
    s_waitcnt vmcnt(12)
    buffer_load_dwordx4 v[180:183], v250, s[52:55], s36 offen nt
    s_cbranch_vccnz L_wd54
    s_waitcnt vmcnt(11)
L_wd54:
    s_waitcnt vmcnt(12)
    s_add_u32 s36, s32, 11
    s_and_b32 s36, s36, 15
    s_lshl_b32 s36, s36, 13
    s_add_u32 s36, s36, 1441792
    buffer_load_dwordx4 v[184:187], v8, s[52:55], s36 offen nt
    s_cbranch_vccnz L_wd55
    s_waitcnt vmcnt(11)
L_wd55:
    s_waitcnt vmcnt(12)
    buffer_load_dwordx4 v[188:191], v250, s[52:55], s36 offen nt
    s_cbranch_vccnz L_wd56
    s_waitcnt vmcnt(11)
L_wd56:
    s_waitcnt vmcnt(12)
    s_add_u32 s36, s32, 12
    s_and_b32 s36, s36, 15
    s_lshl_b32 s36, s36, 13
    s_add_u32 s36, s36, 1572864
    buffer_load_dwordx4 v[192:195], v8, s[52:55], s36 offen nt
    s_cbranch_vccnz L_wd57
    s_waitcnt vmcnt(11)
L_wd57:
    s_waitcnt vmcnt(12)
    buffer_load_dwordx4 v[196:199], v250, s[52:55], s36 offen nt
    s_cbranch_vccnz L_wd58
    s_waitcnt vmcnt(11)
L_wd58:
    s_waitcnt vmcnt(12)
    s_add_u32 s36, s32, 13
    s_and_b32 s36, s36, 15
    s_lshl_b32 s36, s36, 13
    s_add_u32 s36, s36, 1703936
    buffer_load_dwordx4 v[200:203], v8, s[52:55], s36 offen nt
    s_cbranch_vccnz L_wd59
    s_waitcnt vmcnt(11)
L_wd59:
    s_waitcnt vmcnt(12)
    buffer_load_dwordx4 v[204:207], v250, s[52:55], s36 offen nt
    s_cbranch_vccnz L_wd60
    s_waitcnt vmcnt(11)
L_wd60:
    s_waitcnt vmcnt(12)
    s_add_u32 s36, s32, 14
    s_and_b32 s36, s36, 15
    s_lshl_b32 s36, s36, 13
    s_add_u32 s36, s36, 1835008
    buffer_load_dwordx4 v[208:211], v8, s[52:55], s36 offen nt
    s_cbranch_vccnz L_wd61
    s_waitcnt vmcnt(11)
L_wd61:
    s_waitcnt vmcnt(12)
    buffer_load_dwordx4 v[212:215], v250, s[52:55], s36 offen nt
    s_cbranch_vccnz L_wd62
    s_waitcnt vmcnt(11)
L_wd62:
    s_waitcnt vmcnt(12)
    s_add_u32 s36, s32, 15
    s_and_b32 s36, s36, 15
    s_lshl_b32 s36, s36, 13
    s_add_u32 s36, s36, 1966080
    buffer_load_dwordx4 v[216:219], v8, s[52:55], s36 offen nt
    s_cbranch_vccnz L_wd63
    s_waitcnt vmcnt(11)
L_wd63:
    s_waitcnt vmcnt(12)
    buffer_load_dwordx4 v[220:223], v250, s[52:55], s36 offen nt
    s_mov_b64 s[80:81], exec
    s_mov_b64 exec, 1
    ds_add_u32 v1, v2 offset:92
    s_mov_b64 exec, s[80:81]
    s_mov_b64 s[80:81], exec
    s_mov_b64 exec, 1
    ds_add_u32 v1, v2 offset:116
    s_mov_b64 exec, s[80:81]
    v_and_b32 v11, 15, v0
    v_lshrrev_b32 v12, 4, v0
    v_lshrrev_b32 v13, 1, v11
    v_lshlrev_b32 v13, 3, v13
    v_lshl_add_u32 v13, v12, 1, v13
    v_and_b32 v14, 1, v11
    v_add_u32 v13, v13, v14
    v_lshlrev_b32 v13, 6, v13
    v_add_u32 v13, 134144, v13
    v_cmp_gt_u32 vcc, 4, v11
    v_mov_b32 v15, 131072
    s_nop 0
    v_cndmask_b32 v13, v15, v13, vcc
    v_mov_b32 v32, 0
    v_mov_b32 v33, 0
    v_mov_b32 v34, 0
    v_mov_b32 v35, 0
    v_mov_b32 v36, 0
    v_mov_b32 v37, 0
    v_mov_b32 v38, 0
    v_mov_b32 v39, 0
    v_mov_b32 v40, 0
    v_mov_b32 v41, 0
    v_mov_b32 v42, 0
    v_mov_b32 v43, 0
    v_mov_b32 v44, 0
    v_mov_b32 v45, 0
    v_mov_b32 v46, 0
    v_mov_b32 v47, 0
    v_mov_b32 v48, 0
    v_mov_b32 v49, 0
    v_mov_b32 v50, 0
    v_mov_b32 v51, 0
    v_mov_b32 v52, 0
    v_mov_b32 v53, 0
    v_mov_b32 v54, 0
    v_mov_b32 v55, 0
    v_mov_b32 v56, 0
    v_mov_b32 v57, 0
    v_mov_b32 v58, 0
    v_mov_b32 v59, 0
    v_mov_b32 v60, 0
    v_mov_b32 v61, 0
    v_mov_b32 v62, 0
    v_mov_b32 v63, 0
    s_lshl_b32 s36, s29, 2
    s_lshr_b32 s37, s28, 1
    s_add_u32 s36, s36, s37
    s_lshl_b32 s36, s36, 5
    s_add_u32 s36, s36, s30
    s_lshl_b32 s36, s36, 9
    s_and_b32 s37, s28, 1
    s_lshl_b32 s37, s37, 8
    s_add_u32 s36, s36, s37
    s_add_u32 s36, s36, 327680
    v_lshlrev_b32 v4, 5, v0
    v_add_u32 v4, s36, v4
    v_add_u32 v5, 32768, v4
    s_mov_b32 s46, 0
L_lw3:
    ds_read_b32 v11, v1 offset:80
    s_add_u32 s46, s46, 1
    s_waitcnt lgkmcnt(0)
    v_readfirstlane_b32 s47, v11
    s_nop 0
    s_cmp_ge_u32 s47, 4
    s_cbranch_scc1 L_lw3_d
    s_sleep 1
    s_cmp_lt_u32 s46, 0x400000
    s_cbranch_scc1 L_lw3
L_lw3_d:
    ds_read_b32 v11, v1 offset:108
    s_waitcnt lgkmcnt(0)
    v_readfirstlane_b32 s79, v11
    ds_read_b128 v[16:19], v13 offset:0
    ds_read_b128 v[20:23], v13 offset:16
    ds_read_b128 v[24:27], v13 offset:32
    ds_read_b128 v[28:31], v13 offset:48
    v_perm_b32 v64, v100, v96, s33
    v_perm_b32 v68, v100, v96, s34
    v_perm_b32 v72, v101, v97, s33
    v_perm_b32 v76, v101, v97, s34
    v_perm_b32 v80, v102, v98, s33
    v_perm_b32 v84, v102, v98, s34
    v_perm_b32 v88, v103, v99, s33
    v_perm_b32 v92, v103, v99, s34
    v_perm_b32 v65, v108, v104, s33
    v_perm_b32 v69, v108, v104, s34
    v_perm_b32 v73, v109, v105, s33
    v_perm_b32 v77, v109, v105, s34
    v_perm_b32 v81, v110, v106, s33
    v_perm_b32 v85, v110, v106, s34
    v_perm_b32 v89, v111, v107, s33
    v_perm_b32 v93, v111, v107, s34
    v_perm_b32 v66, v116, v112, s33
    v_perm_b32 v70, v116, v112, s34
    v_perm_b32 v74, v117, v113, s33
    v_perm_b32 v78, v117, v113, s34
    v_perm_b32 v82, v118, v114, s33
    v_perm_b32 v86, v118, v114, s34
    v_perm_b32 v90, v119, v115, s33
    v_perm_b32 v94, v119, v115, s34
    v_perm_b32 v67, v124, v120, s33
    v_perm_b32 v71, v124, v120, s34
    v_perm_b32 v75, v125, v121, s33
    v_perm_b32 v79, v125, v121, s34
    v_perm_b32 v83, v126, v122, s33
    v_perm_b32 v87, v126, v122, s34
    v_perm_b32 v91, v127, v123, s33
    v_perm_b32 v95, v127, v123, s34
    s_waitcnt lgkmcnt(0)
    v_mfma_f32_16x16x32_bf16 v[32:35], v[16:19], v[64:67], v[32:35]
    v_mfma_f32_16x16x32_bf16 v[36:39], v[16:19], v[68:71], v[36:39]
    v_mfma_f32_16x16x32_bf16 v[40:43], v[16:19], v[72:75], v[40:43]
    v_mfma_f32_16x16x32_bf16 v[44:47], v[16:19], v[76:79], v[44:47]
    v_mfma_f32_16x16x32_bf16 v[48:51], v[16:19], v[80:83], v[48:51]
    v_mfma_f32_16x16x32_bf16 v[52:55], v[16:19], v[84:87], v[52:55]
    v_mfma_f32_16x16x32_bf16 v[56:59], v[16:19], v[88:91], v[56:59]
    v_mfma_f32_16x16x32_bf16 v[60:63], v[16:19], v[92:95], v[60:63]
    v_perm_b32 v64, v132, v128, s33
    v_perm_b32 v68, v132, v128, s34
    v_perm_b32 v72, v133, v129, s33
    v_perm_b32 v76, v133, v129, s34
    v_perm_b32 v80, v134, v130, s33
    v_perm_b32 v84, v134, v130, s34
    v_perm_b32 v88, v135, v131, s33
    v_perm_b32 v92, v135, v131, s34
    v_perm_b32 v65, v140, v136, s33
    v_perm_b32 v69, v140, v136, s34
    v_perm_b32 v73, v141, v137, s33
    v_perm_b32 v77, v141, v137, s34
    v_perm_b32 v81, v142, v138, s33
    v_perm_b32 v85, v142, v138, s34
    v_perm_b32 v89, v143, v139, s33
    v_perm_b32 v93, v143, v139, s34
    v_perm_b32 v66, v148, v144, s33
    v_perm_b32 v70, v148, v144, s34
    v_perm_b32 v74, v149, v145, s33
    v_perm_b32 v78, v149, v145, s34
    v_perm_b32 v82, v150, v146, s33
    v_perm_b32 v86, v150, v146, s34
    v_perm_b32 v90, v151, v147, s33
    v_perm_b32 v94, v151, v147, s34
    v_perm_b32 v67, v156, v152, s33
    v_perm_b32 v71, v156, v152, s34
    v_perm_b32 v75, v157, v153, s33
    v_perm_b32 v79, v157, v153, s34
    v_perm_b32 v83, v158, v154, s33
    v_perm_b32 v87, v158, v154, s34
    v_perm_b32 v91, v159, v155, s33
    v_perm_b32 v95, v159, v155, s34
    v_mfma_f32_16x16x32_bf16 v[32:35], v[20:23], v[64:67], v[32:35]
    v_mfma_f32_16x16x32_bf16 v[36:39], v[20:23], v[68:71], v[36:39]
    v_mfma_f32_16x16x32_bf16 v[40:43], v[20:23], v[72:75], v[40:43]
    v_mfma_f32_16x16x32_bf16 v[44:47], v[20:23], v[76:79], v[44:47]
    v_mfma_f32_16x16x32_bf16 v[48:51], v[20:23], v[80:83], v[48:51]
    v_mfma_f32_16x16x32_bf16 v[52:55], v[20:23], v[84:87], v[52:55]
    v_mfma_f32_16x16x32_bf16 v[56:59], v[20:23], v[88:91], v[56:59]
    v_mfma_f32_16x16x32_bf16 v[60:63], v[20:23], v[92:95], v[60:63]
    v_perm_b32 v64, v164, v160, s33
    v_perm_b32 v68, v164, v160, s34
    v_perm_b32 v72, v165, v161, s33
    v_perm_b32 v76, v165, v161, s34
    v_perm_b32 v80, v166, v162, s33
    v_perm_b32 v84, v166, v162, s34
    v_perm_b32 v88, v167, v163, s33
    v_perm_b32 v92, v167, v163, s34
    s_waitcnt vmcnt(12)
    v_perm_b32 v65, v172, v168, s33
    v_perm_b32 v69, v172, v168, s34
    v_perm_b32 v73, v173, v169, s33
    v_perm_b32 v77, v173, v169, s34
    v_perm_b32 v81, v174, v170, s33
    v_perm_b32 v85, v174, v170, s34
    v_perm_b32 v89, v175, v171, s33
    v_perm_b32 v93, v175, v171, s34
    s_waitcnt vmcnt(10)
    v_perm_b32 v66, v180, v176, s33
    v_perm_b32 v70, v180, v176, s34
    v_perm_b32 v74, v181, v177, s33
    v_perm_b32 v78, v181, v177, s34
    v_perm_b32 v82, v182, v178, s33
    v_perm_b32 v86, v182, v178, s34
    v_perm_b32 v90, v183, v179, s33
    v_perm_b32 v94, v183, v179, s34
    s_waitcnt vmcnt(8)
    v_perm_b32 v67, v188, v184, s33
    v_perm_b32 v71, v188, v184, s34
    v_perm_b32 v75, v189, v185, s33
    v_perm_b32 v79, v189, v185, s34
    v_perm_b32 v83, v190, v186, s33
    v_perm_b32 v87, v190, v186, s34
    v_perm_b32 v91, v191, v187, s33
    v_perm_b32 v95, v191, v187, s34
    v_mfma_f32_16x16x32_bf16 v[32:35], v[24:27], v[64:67], v[32:35]
    v_mfma_f32_16x16x32_bf16 v[36:39], v[24:27], v[68:71], v[36:39]
    v_mfma_f32_16x16x32_bf16 v[40:43], v[24:27], v[72:75], v[40:43]
    v_mfma_f32_16x16x32_bf16 v[44:47], v[24:27], v[76:79], v[44:47]
    v_mfma_f32_16x16x32_bf16 v[48:51], v[24:27], v[80:83], v[48:51]
    v_mfma_f32_16x16x32_bf16 v[52:55], v[24:27], v[84:87], v[52:55]
    v_mfma_f32_16x16x32_bf16 v[56:59], v[24:27], v[88:91], v[56:59]
    v_mfma_f32_16x16x32_bf16 v[60:63], v[24:27], v[92:95], v[60:63]
    s_waitcnt vmcnt(6)
    v_perm_b32 v64, v196, v192, s33
    v_perm_b32 v68, v196, v192, s34
    v_perm_b32 v72, v197, v193, s33
    v_perm_b32 v76, v197, v193, s34
    v_perm_b32 v80, v198, v194, s33
    v_perm_b32 v84, v198, v194, s34
    v_perm_b32 v88, v199, v195, s33
    v_perm_b32 v92, v199, v195, s34
    s_waitcnt vmcnt(4)
    v_perm_b32 v65, v204, v200, s33
    v_perm_b32 v69, v204, v200, s34
    v_perm_b32 v73, v205, v201, s33
    v_perm_b32 v77, v205, v201, s34
    v_perm_b32 v81, v206, v202, s33
    v_perm_b32 v85, v206, v202, s34
    v_perm_b32 v89, v207, v203, s33
    v_perm_b32 v93, v207, v203, s34
    s_waitcnt vmcnt(2)
    v_perm_b32 v66, v212, v208, s33
    v_perm_b32 v70, v212, v208, s34
    v_perm_b32 v74, v213, v209, s33
    v_perm_b32 v78, v213, v209, s34
    v_perm_b32 v82, v214, v210, s33
    v_perm_b32 v86, v214, v210, s34
    v_perm_b32 v90, v215, v211, s33
    v_perm_b32 v94, v215, v211, s34
    s_waitcnt vmcnt(0)
    v_perm_b32 v67, v220, v216, s33
    v_perm_b32 v71, v220, v216, s34
    v_perm_b32 v75, v221, v217, s33
    v_perm_b32 v79, v221, v217, s34
    v_perm_b32 v83, v222, v218, s33
    v_perm_b32 v87, v222, v218, s34
    v_perm_b32 v91, v223, v219, s33
    v_perm_b32 v95, v223, v219, s34
    v_mfma_f32_16x16x32_bf16 v[32:35], v[28:31], v[64:67], v[32:35]
    v_mfma_f32_16x16x32_bf16 v[36:39], v[28:31], v[68:71], v[36:39]
    v_mfma_f32_16x16x32_bf16 v[40:43], v[28:31], v[72:75], v[40:43]
    v_mfma_f32_16x16x32_bf16 v[44:47], v[28:31], v[76:79], v[44:47]
    v_mfma_f32_16x16x32_bf16 v[48:51], v[28:31], v[80:83], v[48:51]
    v_mfma_f32_16x16x32_bf16 v[52:55], v[28:31], v[84:87], v[52:55]
    v_mfma_f32_16x16x32_bf16 v[56:59], v[28:31], v[88:91], v[56:59]
    v_mfma_f32_16x16x32_bf16 v[60:63], v[28:31], v[92:95], v[60:63]
    s_nop 0
    v_add_f32_dpp v64, v33, v32 row_shl:8 row_mask:0xf bank_mask:0xf bound_ctrl:0
    v_add_f32_dpp v65, v37, v36 row_shl:8 row_mask:0xf bank_mask:0xf bound_ctrl:0
    v_add_f32_dpp v66, v41, v40 row_shl:8 row_mask:0xf bank_mask:0xf bound_ctrl:0
    v_add_f32_dpp v67, v45, v44 row_shl:8 row_mask:0xf bank_mask:0xf bound_ctrl:0
    v_add_f32_dpp v68, v49, v48 row_shl:8 row_mask:0xf bank_mask:0xf bound_ctrl:0
    v_add_f32_dpp v69, v53, v52 row_shl:8 row_mask:0xf bank_mask:0xf bound_ctrl:0
    v_add_f32_dpp v70, v57, v56 row_shl:8 row_mask:0xf bank_mask:0xf bound_ctrl:0
    v_add_f32_dpp v71, v61, v60 row_shl:8 row_mask:0xf bank_mask:0xf bound_ctrl:0
    v_add_f32_dpp v72, v35, v34 row_shl:8 row_mask:0xf bank_mask:0xf bound_ctrl:0
    v_add_f32_dpp v73, v39, v38 row_shl:8 row_mask:0xf bank_mask:0xf bound_ctrl:0
    v_add_f32_dpp v74, v43, v42 row_shl:8 row_mask:0xf bank_mask:0xf bound_ctrl:0
    v_add_f32_dpp v75, v47, v46 row_shl:8 row_mask:0xf bank_mask:0xf bound_ctrl:0
    v_add_f32_dpp v76, v51, v50 row_shl:8 row_mask:0xf bank_mask:0xf bound_ctrl:0
    v_add_f32_dpp v77, v55, v54 row_shl:8 row_mask:0xf bank_mask:0xf bound_ctrl:0
    v_add_f32_dpp v78, v59, v58 row_shl:8 row_mask:0xf bank_mask:0xf bound_ctrl:0
    v_add_f32_dpp v79, v63, v62 row_shl:8 row_mask:0xf bank_mask:0xf bound_ctrl:0
    v_min_u32 v64, -2, v64
    v_min_u32 v65, -2, v65
    v_min_u32 v66, -2, v66
    v_min_u32 v67, -2, v67
    v_min_u32 v68, -2, v68
    v_min_u32 v69, -2, v69
    v_min_u32 v70, -2, v70
    v_min_u32 v71, -2, v71
    v_min_u32 v72, -2, v72
    v_min_u32 v73, -2, v73
    v_min_u32 v74, -2, v74
    v_min_u32 v75, -2, v75
    v_min_u32 v76, -2, v76
    v_min_u32 v77, -2, v77
    v_min_u32 v78, -2, v78
    v_min_u32 v79, -2, v79
    s_mov_b64 exec, 0xff
    s_cmp_eq_u32 s79, 2
    s_cbranch_scc1 L_opst_f
    global_store_dwordx4 v4, v[64:67], s[26:27] offset:0 sc1
    global_store_dwordx4 v4, v[68:71], s[26:27] offset:16 sc1
    global_store_dwordx4 v5, v[72:75], s[26:27] offset:0 sc1
    global_store_dwordx4 v5, v[76:79], s[26:27] offset:16 sc1
    s_branch L_opst_d
L_opst_f:
    global_store_dwordx4 v4, v[64:67], s[26:27] offset:0
    global_store_dwordx4 v4, v[68:71], s[26:27] offset:16
    global_store_dwordx4 v5, v[72:75], s[26:27] offset:0
    global_store_dwordx4 v5, v[76:79], s[26:27] offset:16
L_opst_d:
    s_mov_b64 exec, -1
    s_mov_b64 s[80:81], exec
    s_mov_b64 exec, 1
    ds_add_u32 v1, v2 offset:96
    s_mov_b64 exec, s[80:81]
    s_endpgm
L_service:
    s_mov_b32 s66, 0
    s_mov_b32 s67, 0
    s_mov_b32 s68, 0
    s_mov_b32 s69, 0
    s_mov_b32 s70, 0
    s_mov_b32 s79, 0
    s_setprio 2
    s_cmp_eq_u32 s28, 7
    s_cbranch_scc1 L_w7
    s_cmp_eq_u32 s28, 6
    s_cbranch_scc1 L_w6
    v_and_b32 v3, 15, v0
    v_lshrrev_b32 v4, 4, v0
    v_lshrrev_b32 v6, 5, v0
    v_mul_u32_u24 v6, 896, v6
    v_and_b32 v7, 31, v0
    v_mul_u32_u24 v7, 28, v7
    v_add_u32 v6, v6, v7
    s_waitcnt lgkmcnt(0)
    global_load_dwordx4 v[16:19], v6, s[4:5]
    global_load_dwordx3 v[20:22], v6, s[4:5] offset:16
    s_barrier
    s_cmp_eq_u32 s28, 5
    s_cbranch_scc1 L_p5
    s_lshr_b32 s64, s30, 3
    s_and_b32 s36, s30, 7
    s_lshl_b32 s65, s29, 3
    s_add_u32 s65, s65, s64
    s_lshl_b32 s65, s65, 3
    s_add_u32 s65, s65, s36
    s_lshl_b32 s65, s65, 8
    s_add_u32 s65, s65, 65536
    s_mov_b32 s66, 8192
    s_mov_b32 s67, 1
    s_mov_b32 s68, 98304
    s_branch L_p45
L_p5:
    s_and_b32 s64, s30, 3
    s_lshl_b32 s65, s29, 5
    s_add_u32 s65, s65, s30
    s_lshl_b32 s65, s65, 9
    s_add_u32 s65, s65, 196608
    s_mov_b32 s66, 256
    s_mov_b32 s68, 112640
    s_cmp_lt_u32 s29, 7
    s_cselect_b32 s67, 1, 0
L_p45:
    s_cmp_eq_u32 s67, 0
    s_cbranch_scc1 L_s1_skip
    s_waitcnt vmcnt(0)
    v_lshlrev_b32 v24, 16, v16
    v_and_b32 v25, 0xffff0000, v16
    v_lshlrev_b32 v26, 16, v17
    v_and_b32 v27, 0xffff0000, v17
    v_lshlrev_b32 v28, 16, v18
    v_and_b32 v29, 0xffff0000, v18
    v_lshlrev_b32 v30, 16, v19
    v_and_b32 v31, 0xffff0000, v19
    v_lshlrev_b32 v32, 16, v20
    v_and_b32 v33, 0xffff0000, v20
    v_lshlrev_b32 v34, 16, v21
    v_and_b32 v35, 0xffff0000, v21
    v_lshlrev_b32 v36, 16, v22
    v_and_b32 v37, 0xffff0000, v22
    v_add_f32 v8, v24, v25
    v_add_f32 v8, v8, v26
    v_add_f32 v8, v8, v27
    v_add_f32 v8, v8, v28
    v_add_f32 v8, v8, v29
    v_add_f32 v8, v8, v30
    v_add_f32 v8, v8, v31
    v_add_f32 v8, v8, v32
    v_add_f32 v8, v8, v33
    v_add_f32 v8, v8, v34
    v_add_f32 v8, v8, v35
    v_add_f32 v8, v8, v36
    v_add_f32 v8, v8, v37
    s_nop 1
    v_add_f32_dpp v8, v8, v8 quad_perm:[1,0,3,2] row_mask:0xf bank_mask:0xf
    s_nop 1
    v_add_f32_dpp v8, v8, v8 quad_perm:[2,3,0,1] row_mask:0xf bank_mask:0xf
    s_nop 1
    v_add_f32_dpp v8, v8, v8 row_half_mirror row_mask:0xf bank_mask:0xf
    s_nop 1
    v_add_f32_dpp v8, v8, v8 row_mirror row_mask:0xf bank_mask:0xf
    v_mov_b32 v13, v8
    s_nop 1
    v_permlane16_swap_b32 v8, v13
    v_add_f32 v8, v8, v13
    s_mov_b32 s36, 0x3b124925
    s_mov_b32 s37, 0xc3e00000
    v_mul_f32 v10, s36, v8
    v_fma_f32 v13, v10, s37, v8
    v_fma_f32 v10, v13, s36, v10
    v_cvt_pk_bf16_f32 v9, v10, v10
    v_lshlrev_b32 v9, 16, v9
    v_sub_f32 v13, v24, v10
    v_mul_f32 v11, v13, v13
    v_sub_f32 v13, v25, v10
    v_fmac_f32 v11, v13, v13
    v_sub_f32 v13, v26, v10
    v_fmac_f32 v11, v13, v13
    v_sub_f32 v13, v27, v10
    v_fmac_f32 v11, v13, v13
    v_sub_f32 v13, v28, v10
    v_fmac_f32 v11, v13, v13
    v_sub_f32 v13, v29, v10
    v_fmac_f32 v11, v13, v13
    v_sub_f32 v13, v30, v10
    v_fmac_f32 v11, v13, v13
    v_sub_f32 v13, v31, v10
    v_fmac_f32 v11, v13, v13
    v_sub_f32 v13, v32, v10
    v_fmac_f32 v11, v13, v13
    v_sub_f32 v13, v33, v10
    v_fmac_f32 v11, v13, v13
    v_sub_f32 v13, v34, v10
    v_fmac_f32 v11, v13, v13
    v_sub_f32 v13, v35, v10
    v_fmac_f32 v11, v13, v13
    v_sub_f32 v13, v36, v10
    v_fmac_f32 v11, v13, v13
    v_sub_f32 v13, v37, v10
    v_fmac_f32 v11, v13, v13
    s_nop 1
    v_add_f32_dpp v11, v11, v11 quad_perm:[1,0,3,2] row_mask:0xf bank_mask:0xf
    s_nop 1
    v_add_f32_dpp v11, v11, v11 quad_perm:[2,3,0,1] row_mask:0xf bank_mask:0xf
    s_nop 1
    v_add_f32_dpp v11, v11, v11 row_half_mirror row_mask:0xf bank_mask:0xf
    s_nop 1
    v_add_f32_dpp v11, v11, v11 row_mirror row_mask:0xf bank_mask:0xf
    v_mov_b32 v13, v11
    s_nop 1
    v_permlane16_swap_b32 v11, v13
    v_add_f32 v11, v11, v13
    v_mul_f32 v8, s36, v11
    v_fma_f32 v13, v8, s37, v11
    v_fma_f32 v8, v13, s36, v8
    v_cvt_pk_bf16_f32 v8, v8, v8
    v_lshlrev_b32 v8, 16, v8
    v_add_f32 v8, 0x3727c5ac, v8
    v_cvt_pk_bf16_f32 v8, v8, v8
    v_lshlrev_b32 v8, 16, v8
    v_sqrt_f32 v8, v8
    s_nop 0
    v_cvt_pk_bf16_f32 v8, v8, v8
    v_lshlrev_b32 v8, 16, v8
    v_rcp_f32 v12, v8
    v_sub_f32 v24, v24, v9
    v_sub_f32 v25, v25, v9
    v_cvt_pk_bf16_f32 v13, v24, v25
    v_lshlrev_b32 v24, 16, v13
    v_and_b32 v25, 0xffff0000, v13
    v_mul_f32 v14, v24, v12
    v_fma_f32 v15, -v14, v8, v24
    v_fma_f32 v24, v15, v12, v14
    v_mul_f32 v14, v25, v12
    v_fma_f32 v15, -v14, v8, v25
    v_fma_f32 v25, v15, v12, v14
    v_cvt_pk_bf16_f32 v16, v24, v25
    v_sub_f32 v26, v26, v9
    v_sub_f32 v27, v27, v9
    v_cvt_pk_bf16_f32 v13, v26, v27
    v_lshlrev_b32 v26, 16, v13
    v_and_b32 v27, 0xffff0000, v13
    v_mul_f32 v14, v26, v12
    v_fma_f32 v15, -v14, v8, v26
    v_fma_f32 v26, v15, v12, v14
    v_mul_f32 v14, v27, v12
    v_fma_f32 v15, -v14, v8, v27
    v_fma_f32 v27, v15, v12, v14
    v_cvt_pk_bf16_f32 v17, v26, v27
    v_sub_f32 v28, v28, v9
    v_sub_f32 v29, v29, v9
    v_cvt_pk_bf16_f32 v13, v28, v29
    v_lshlrev_b32 v28, 16, v13
    v_and_b32 v29, 0xffff0000, v13
    v_mul_f32 v14, v28, v12
    v_fma_f32 v15, -v14, v8, v28
    v_fma_f32 v28, v15, v12, v14
    v_mul_f32 v14, v29, v12
    v_fma_f32 v15, -v14, v8, v29
    v_fma_f32 v29, v15, v12, v14
    v_cvt_pk_bf16_f32 v18, v28, v29
    v_sub_f32 v30, v30, v9
    v_sub_f32 v31, v31, v9
    v_cvt_pk_bf16_f32 v13, v30, v31
    v_lshlrev_b32 v30, 16, v13
    v_and_b32 v31, 0xffff0000, v13
    v_mul_f32 v14, v30, v12
    v_fma_f32 v15, -v14, v8, v30
    v_fma_f32 v30, v15, v12, v14
    v_mul_f32 v14, v31, v12
    v_fma_f32 v15, -v14, v8, v31
    v_fma_f32 v31, v15, v12, v14
    v_cvt_pk_bf16_f32 v19, v30, v31
    v_sub_f32 v32, v32, v9
    v_sub_f32 v33, v33, v9
    v_cvt_pk_bf16_f32 v13, v32, v33
    v_lshlrev_b32 v32, 16, v13
    v_and_b32 v33, 0xffff0000, v13
    v_mul_f32 v14, v32, v12
    v_fma_f32 v15, -v14, v8, v32
    v_fma_f32 v32, v15, v12, v14
    v_mul_f32 v14, v33, v12
    v_fma_f32 v15, -v14, v8, v33
    v_fma_f32 v33, v15, v12, v14
    v_cvt_pk_bf16_f32 v20, v32, v33
    v_sub_f32 v34, v34, v9
    v_sub_f32 v35, v35, v9
    v_cvt_pk_bf16_f32 v13, v34, v35
    v_lshlrev_b32 v34, 16, v13
    v_and_b32 v35, 0xffff0000, v13
    v_mul_f32 v14, v34, v12
    v_fma_f32 v15, -v14, v8, v34
    v_fma_f32 v34, v15, v12, v14
    v_mul_f32 v14, v35, v12
    v_fma_f32 v15, -v14, v8, v35
    v_fma_f32 v35, v15, v12, v14
    v_cvt_pk_bf16_f32 v21, v34, v35
    v_sub_f32 v36, v36, v9
    v_sub_f32 v37, v37, v9
    v_cvt_pk_bf16_f32 v13, v36, v37
    v_lshlrev_b32 v36, 16, v13
    v_and_b32 v37, 0xffff0000, v13
    v_mul_f32 v14, v36, v12
    v_fma_f32 v15, -v14, v8, v36
    v_fma_f32 v36, v15, v12, v14
    v_mul_f32 v14, v37, v12
    v_fma_f32 v15, -v14, v8, v37
    v_fma_f32 v37, v15, v12, v14
    v_cvt_pk_bf16_f32 v22, v36, v37
    v_add_u32 v6, 131328, v6
    ds_write_b32 v6, v16 offset:0
    ds_write_b32 v6, v17 offset:4
    ds_write_b32 v6, v18 offset:8
    ds_write_b32 v6, v19 offset:12
    ds_write_b32 v6, v20 offset:16
    ds_write_b32 v6, v21 offset:20
    ds_write_b32 v6, v22 offset:24
    s_mul_i32 s36, s64, 224
    v_mul_u32_u24 v7, 896, v3
    v_lshl_add_u32 v7, v4, 3, v7
    v_add_u32 v7, s36, v7
    v_add_u32 v7, 131328, v7
    v_cmp_gt_u32 vcc, 2, v3
    v_mov_b32 v96, 0
    v_mov_b32 v97, 0
    v_mov_b32 v98, 0
    v_mov_b32 v99, 0
    v_mov_b32 v100, 0
    v_mov_b32 v101, 0
    v_mov_b32 v102, 0
    v_mov_b32 v103, 0
    v_mov_b32 v104, 0
    v_mov_b32 v105, 0
    v_mov_b32 v106, 0
    v_mov_b32 v107, 0
    v_mov_b32 v108, 0
    v_mov_b32 v109, 0
    s_mov_b64 exec, vcc
    ds_read_b64 v[96:97], v7 offset:0
    ds_read_b64 v[98:99], v7 offset:32
    ds_read_b64 v[100:101], v7 offset:64
    ds_read_b64 v[102:103], v7 offset:96
    ds_read_b64 v[104:105], v7 offset:128
    ds_read_b64 v[106:107], v7 offset:160
    ds_read_b64 v[108:109], v7 offset:192
    s_mov_b64 exec, -1
    v_mov_b32 v128, 0
    v_mov_b32 v129, 0
    v_mov_b32 v130, 0
    v_mov_b32 v131, 0
    v_mov_b32 v132, 0
    v_mov_b32 v133, 0
    v_mov_b32 v134, 0
    v_mov_b32 v135, 0
    v_mov_b32 v136, 0
    v_mov_b32 v137, 0
    v_mov_b32 v138, 0
    v_mov_b32 v139, 0
    v_mov_b32 v140, 0
    v_mov_b32 v141, 0
    v_mov_b32 v142, 0
    v_mov_b32 v143, 0
    v_lshlrev_b32 v5, 9, v4
    v_lshl_add_u32 v5, v3, 3, v5
    v_add_u32 v5, s68, v5
    s_cmp_eq_u32 s28, 4
    s_cbranch_scc0 L_w45w
    s_mov_b32 s46, 0
L_lw4:
    ds_read_b32 v8, v1 offset:68
    s_add_u32 s46, s46, 1
    s_waitcnt lgkmcnt(0)
    v_readfirstlane_b32 s47, v8
    s_nop 0
    s_cmp_ge_u32 s47, 1
    s_cbranch_scc1 L_lw4_d
    s_sleep 1
    s_cmp_lt_u32 s46, 0x400000
    s_cbranch_scc1 L_lw4
L_lw4_d:
    ds_read_b64 v[8:9], v1 offset:128
    v_and_b32 v6, 31, v0
    s_lshl_b32 s36, s29, 5
    v_add_u32 v6, s36, v6
    v_lshlrev_b32 v6, 7, v6
    v_add_u32 v7, 1146880, v6
    v_add_u32 v6, 4096, v6
    s_waitcnt lgkmcnt(0)
    s_mov_b32 s82, 0
L_pf4:
    s_add_u32 s82, s82, 1
    s_cmp_le_u32 s82, 5
    s_cbranch_scc1 L_pf4_l
    s_and_b32 s39, s82, 1
    s_cbranch_scc0 L_pf4_g
L_pf4_l:
    global_load_dwordx2 v[10:11], v7, s[26:27] sc1
    s_branch L_pf4_t
L_pf4_g:
    global_load_dwordx2 v[10:11], v6, s[26:27] sc1
L_pf4_t:
    s_waitcnt vmcnt(0)
    v_and_b32 v12, -16, v10
    v_xor_b32 v12, v12, v8
    v_xor_b32 v11, v11, v9
    v_or_b32 v12, v12, v11
    v_cmp_ne_u32 vcc, 0, v12
    s_nop 0
    s_cmp_eq_u64 vcc, 0
    s_cbranch_scc1 L_pf4_d
    s_sleep 2
    s_cmp_lt_u32 s82, 65536
    s_cbranch_scc1 L_pf4
L_pf4_d:
    s_getreg_b32 s36, hwreg(HW_REG_XCC_ID, 0, 4)
    v_and_b32 v10, 15, v10
    v_cmp_ne_u32 vcc, s36, v10
    s_nop 0
    s_cmp_eq_u64 vcc, 0
    s_cselect_b32 s79, 2, 1
    v_mov_b32 v11, s79
    s_mov_b64 exec, 1
    ds_write_b32 v1, v11 offset:108
    ds_add_u32 v1, v2 offset:88
    s_mov_b64 exec, -1
L_w45w:
    s_mov_b32 s46, 0
L_lw5:
    ds_read_b32 v8, v1 offset:100
    s_add_u32 s46, s46, 1
    s_waitcnt lgkmcnt(0)
    v_readfirstlane_b32 s47, v8
    s_nop 0
    s_cmp_ge_u32 s47, 4
    s_cbranch_scc1 L_lw5_d
    s_sleep 1
    s_cmp_lt_u32 s46, 0x400000
    s_cbranch_scc1 L_lw5
L_lw5_d:
    ds_read_b64 v[40:41], v5 offset:0
    ds_read_b64 v[42:43], v5 offset:128
    ds_read_b64 v[44:45], v5 offset:256
    ds_read_b64 v[46:47], v5 offset:384
    ds_read_b64 v[48:49], v5 offset:2048
    ds_read_b64 v[50:51], v5 offset:2176
    ds_read_b64 v[52:53], v5 offset:2304
    ds_read_b64 v[54:55], v5 offset:2432
    ds_read_b64 v[56:57], v5 offset:4096
    ds_read_b64 v[58:59], v5 offset:4224
    ds_read_b64 v[60:61], v5 offset:4352
    ds_read_b64 v[62:63], v5 offset:4480
    ds_read_b64 v[64:65], v5 offset:6144
    ds_read_b64 v[66:67], v5 offset:6272
    ds_read_b64 v[68:69], v5 offset:6400
    ds_read_b64 v[70:71], v5 offset:6528
    ds_read_b64 v[72:73], v5 offset:8192
    ds_read_b64 v[74:75], v5 offset:8320
    ds_read_b64 v[76:77], v5 offset:8448
    ds_read_b64 v[78:79], v5 offset:8576
    ds_read_b64 v[80:81], v5 offset:10240
    ds_read_b64 v[82:83], v5 offset:10368
    ds_read_b64 v[84:85], v5 offset:10496
    ds_read_b64 v[86:87], v5 offset:10624
    ds_read_b64 v[88:89], v5 offset:12288
    ds_read_b64 v[90:91], v5 offset:12416
    ds_read_b64 v[92:93], v5 offset:12544
    ds_read_b64 v[94:95], v5 offset:12672
    s_waitcnt lgkmcnt(15)
    v_perm_b32 v112, v42, v40, s33
    v_perm_b32 v114, v42, v40, s34
    v_perm_b32 v116, v43, v41, s33
    v_perm_b32 v118, v43, v41, s34
    v_perm_b32 v113, v46, v44, s33
    v_perm_b32 v115, v46, v44, s34
    v_perm_b32 v117, v47, v45, s33
    v_perm_b32 v119, v47, v45, s34
    v_mfma_f32_16x16x16_bf16 v[128:131], v[96:97], v[112:113], v[128:131]
    v_mfma_f32_16x16x16_bf16 v[132:135], v[96:97], v[114:115], v[132:135]
    v_mfma_f32_16x16x16_bf16 v[136:139], v[96:97], v[116:117], v[136:139]
    v_mfma_f32_16x16x16_bf16 v[140:143], v[96:97], v[118:119], v[140:143]
    s_waitcnt lgkmcnt(15)
    v_perm_b32 v120, v50, v48, s33
    v_perm_b32 v122, v50, v48, s34
    v_perm_b32 v124, v51, v49, s33
    v_perm_b32 v126, v51, v49, s34
    v_perm_b32 v121, v54, v52, s33
    v_perm_b32 v123, v54, v52, s34
    v_perm_b32 v125, v55, v53, s33
    v_perm_b32 v127, v55, v53, s34
    v_mfma_f32_16x16x16_bf16 v[128:131], v[98:99], v[120:121], v[128:131]
    v_mfma_f32_16x16x16_bf16 v[132:135], v[98:99], v[122:123], v[132:135]
    v_mfma_f32_16x16x16_bf16 v[136:139], v[98:99], v[124:125], v[136:139]
    v_mfma_f32_16x16x16_bf16 v[140:143], v[98:99], v[126:127], v[140:143]
    s_waitcnt lgkmcnt(15)
    v_perm_b32 v112, v58, v56, s33
    v_perm_b32 v114, v58, v56, s34
    v_perm_b32 v116, v59, v57, s33
    v_perm_b32 v118, v59, v57, s34
    v_perm_b32 v113, v62, v60, s33
    v_perm_b32 v115, v62, v60, s34
    v_perm_b32 v117, v63, v61, s33
    v_perm_b32 v119, v63, v61, s34
    v_mfma_f32_16x16x16_bf16 v[128:131], v[100:101], v[112:113], v[128:131]
    v_mfma_f32_16x16x16_bf16 v[132:135], v[100:101], v[114:115], v[132:135]
    v_mfma_f32_16x16x16_bf16 v[136:139], v[100:101], v[116:117], v[136:139]
    v_mfma_f32_16x16x16_bf16 v[140:143], v[100:101], v[118:119], v[140:143]
    s_waitcnt lgkmcnt(12)
    v_perm_b32 v120, v66, v64, s33
    v_perm_b32 v122, v66, v64, s34
    v_perm_b32 v124, v67, v65, s33
    v_perm_b32 v126, v67, v65, s34
    v_perm_b32 v121, v70, v68, s33
    v_perm_b32 v123, v70, v68, s34
    v_perm_b32 v125, v71, v69, s33
    v_perm_b32 v127, v71, v69, s34
    v_mfma_f32_16x16x16_bf16 v[128:131], v[102:103], v[120:121], v[128:131]
    v_mfma_f32_16x16x16_bf16 v[132:135], v[102:103], v[122:123], v[132:135]
    v_mfma_f32_16x16x16_bf16 v[136:139], v[102:103], v[124:125], v[136:139]
    v_mfma_f32_16x16x16_bf16 v[140:143], v[102:103], v[126:127], v[140:143]
    s_waitcnt lgkmcnt(8)
    v_perm_b32 v112, v74, v72, s33
    v_perm_b32 v114, v74, v72, s34
    v_perm_b32 v116, v75, v73, s33
    v_perm_b32 v118, v75, v73, s34
    v_perm_b32 v113, v78, v76, s33
    v_perm_b32 v115, v78, v76, s34
    v_perm_b32 v117, v79, v77, s33
    v_perm_b32 v119, v79, v77, s34
    v_mfma_f32_16x16x16_bf16 v[128:131], v[104:105], v[112:113], v[128:131]
    v_mfma_f32_16x16x16_bf16 v[132:135], v[104:105], v[114:115], v[132:135]
    v_mfma_f32_16x16x16_bf16 v[136:139], v[104:105], v[116:117], v[136:139]
    v_mfma_f32_16x16x16_bf16 v[140:143], v[104:105], v[118:119], v[140:143]
    s_waitcnt lgkmcnt(4)
    v_perm_b32 v120, v82, v80, s33
    v_perm_b32 v122, v82, v80, s34
    v_perm_b32 v124, v83, v81, s33
    v_perm_b32 v126, v83, v81, s34
    v_perm_b32 v121, v86, v84, s33
    v_perm_b32 v123, v86, v84, s34
    v_perm_b32 v125, v87, v85, s33
    v_perm_b32 v127, v87, v85, s34
    v_mfma_f32_16x16x16_bf16 v[128:131], v[106:107], v[120:121], v[128:131]
    v_mfma_f32_16x16x16_bf16 v[132:135], v[106:107], v[122:123], v[132:135]
    v_mfma_f32_16x16x16_bf16 v[136:139], v[106:107], v[124:125], v[136:139]
    v_mfma_f32_16x16x16_bf16 v[140:143], v[106:107], v[126:127], v[140:143]
    s_waitcnt lgkmcnt(0)
    v_perm_b32 v112, v90, v88, s33
    v_perm_b32 v114, v90, v88, s34
    v_perm_b32 v116, v91, v89, s33
    v_perm_b32 v118, v91, v89, s34
    v_perm_b32 v113, v94, v92, s33
    v_perm_b32 v115, v94, v92, s34
    v_perm_b32 v117, v95, v93, s33
    v_perm_b32 v119, v95, v93, s34
    s_mov_b64 s[80:81], exec
    s_mov_b64 exec, 1
    ds_add_u32 v1, v2 offset:104
    s_mov_b64 exec, s[80:81]
    v_mfma_f32_16x16x16_bf16 v[128:131], v[108:109], v[112:113], v[128:131]
    v_mfma_f32_16x16x16_bf16 v[132:135], v[108:109], v[114:115], v[132:135]
    v_mfma_f32_16x16x16_bf16 v[136:139], v[108:109], v[116:117], v[136:139]
    v_mfma_f32_16x16x16_bf16 v[140:143], v[108:109], v[118:119], v[140:143]
    v_lshlrev_b32 v14, 4, v3
    v_add_u32 v14, s65, v14
    s_cmp_eq_u32 s28, 4
    s_cbranch_scc1 L_w4f
    s_mov_b32 s46, 0
L_lw6:
    ds_read_b32 v8, v1 offset:88
    s_add_u32 s46, s46, 1
    s_waitcnt lgkmcnt(0)
    v_readfirstlane_b32 s47, v8
    s_nop 0
    s_cmp_ge_u32 s47, 1
    s_cbranch_scc1 L_lw6_d
    s_sleep 1
    s_cmp_lt_u32 s46, 0x400000
    s_cbranch_scc1 L_lw6
L_lw6_d:
    ds_read_b32 v8, v1 offset:108
    s_waitcnt lgkmcnt(0)
    v_readfirstlane_b32 s79, v8
    v_min_u32 v112, -2, v128
    v_min_u32 v113, -2, v132
    v_min_u32 v114, -2, v136
    v_min_u32 v115, -2, v140
    v_min_u32 v116, -2, v129
    v_min_u32 v117, -2, v133
    v_min_u32 v118, -2, v137
    v_min_u32 v119, -2, v141
    v_add_u32 v15, s66, v14
    s_mov_b64 exec, 0xffff
    s_cmp_eq_u32 s79, 2
    s_cbranch_scc1 L_pub5_f
    global_store_dwordx4 v14, v[112:115], s[26:27] sc1
    global_store_dwordx4 v15, v[116:119], s[26:27] sc1
    s_branch L_pub5_d
L_pub5_f:
    global_store_dwordx4 v14, v[112:115], s[26:27]
    global_store_dwordx4 v15, v[116:119], s[26:27]
L_pub5_d:
    s_mov_b64 exec, -1
    s_branch L_qk
L_s1_skip:
    s_mov_b64 s[80:81], exec
    s_mov_b64 exec, 1
    ds_add_u32 v1, v2 offset:104
    s_mov_b64 exec, s[80:81]
    s_branch L_qk
L_w4f:
    s_mov_b32 s46, 0
L_lw7:
    ds_read_b32 v8, v1 offset:120
    s_add_u32 s46, s46, 1
    s_waitcnt lgkmcnt(0)
    v_readfirstlane_b32 s47, v8
    s_nop 0
    s_cmp_ge_u32 s47, 1
    s_cbranch_scc1 L_lw7_d
    s_sleep 1
    s_cmp_lt_u32 s46, 0x400000
    s_cbranch_scc1 L_lw7
L_lw7_d:
    v_min_u32 v112, -2, v128
    v_min_u32 v113, -2, v132
    v_min_u32 v114, -2, v136
    v_min_u32 v115, -2, v140
    v_min_u32 v116, -2, v129
    v_min_u32 v117, -2, v133
    v_min_u32 v118, -2, v137
    v_min_u32 v119, -2, v141
    v_add_u32 v15, s66, v14
    s_mov_b64 exec, 0xffff
    s_cmp_eq_u32 s79, 2
    s_cbranch_scc1 L_pub4_f
    global_store_dwordx4 v14, v[112:115], s[26:27] sc1
    global_store_dwordx4 v15, v[116:119], s[26:27] sc1
    s_branch L_pub4_d
L_pub4_f:
    global_store_dwordx4 v14, v[112:115], s[26:27]
    global_store_dwordx4 v15, v[116:119], s[26:27]
L_pub4_d:
    s_mov_b64 exec, -1
    s_lshl_b32 s36, s29, 1
    s_add_u32 s36, s36, s31
    s_lshl_b32 s36, s36, 13
    s_add_u32 s36, s36, 65536
    v_lshlrev_b32 v6, 5, v0
    v_add_u32 v6, s36, v6
    v_add_u32 v7, 4096, v6
    s_mov_b32 s82, 0
L_qg:
    global_load_dwordx4 v[40:43], v6, s[26:27] offset:0 sc1
    global_load_dwordx4 v[44:47], v6, s[26:27] offset:16 sc1
    global_load_dwordx4 v[48:51], v6, s[26:27] offset:2048 sc1
    global_load_dwordx4 v[52:55], v6, s[26:27] offset:2064 sc1
    global_load_dwordx4 v[56:59], v7, s[26:27] offset:0 sc1
    global_load_dwordx4 v[60:63], v7, s[26:27] offset:16 sc1
    global_load_dwordx4 v[64:67], v7, s[26:27] offset:2048 sc1
    global_load_dwordx4 v[68:71], v7, s[26:27] offset:2064 sc1
    s_add_u32 s82, s82, 1
    s_waitcnt vmcnt(0)
    v_max3_u32 v8, v40, v41, v42
    v_max3_u32 v8, v8, v43, v44
    v_max3_u32 v8, v8, v45, v46
    v_max3_u32 v8, v8, v47, v48
    v_max3_u32 v8, v8, v49, v50
    v_max3_u32 v8, v8, v51, v52
    v_max3_u32 v8, v8, v53, v54
    v_max3_u32 v8, v8, v55, v56
    v_max3_u32 v8, v8, v57, v58
    v_max3_u32 v8, v8, v59, v60
    v_max3_u32 v8, v8, v61, v62
    v_max3_u32 v8, v8, v63, v64
    v_max3_u32 v8, v8, v65, v66
    v_max3_u32 v8, v8, v67, v68
    v_max3_u32 v8, v8, v69, v70
    v_max_u32 v8, v8, v71
    v_cmp_eq_u32 vcc, -1, v8
    s_nop 0
    s_cmp_eq_u64 vcc, 0
    s_cbranch_scc1 L_qg_d
    s_sleep 2
    s_cmp_lt_u32 s82, 65536
    s_cbranch_scc1 L_qg
L_qg_d:
    v_add_f32 v40, v40, v48
    v_add_f32 v56, v56, v64
    v_add_f32 v41, v41, v49
    v_add_f32 v57, v57, v65
    v_add_f32 v42, v42, v50
    v_add_f32 v58, v58, v66
    v_add_f32 v43, v43, v51
    v_add_f32 v59, v59, v67
    v_add_f32 v44, v44, v52
    v_add_f32 v60, v60, v68
    v_add_f32 v45, v45, v53
    v_add_f32 v61, v61, v69
    v_add_f32 v46, v46, v54
    v_add_f32 v62, v62, v70
    v_add_f32 v47, v47, v55
    v_add_f32 v63, v63, v71
    v_add_f32 v40, v40, v56
    v_add_f32 v41, v41, v57
    v_add_f32 v42, v42, v58
    v_add_f32 v43, v43, v59
    v_add_f32 v44, v44, v60
    v_add_f32 v45, v45, v61
    v_add_f32 v46, v46, v62
    v_add_f32 v47, v47, v63
    v_cvt_pk_bf16_f32 v48, v40, v41
    v_cvt_pk_bf16_f32 v49, v42, v43
    v_cvt_pk_bf16_f32 v50, v44, v45
    v_cvt_pk_bf16_f32 v51, v46, v47
    v_lshlrev_b32 v6, 4, v0
    v_add_u32 v6, 133120, v6
    ds_write_b128 v6, v[48:51]
    s_waitcnt lgkmcnt(0)
    s_mov_b64 s[80:81], exec
    s_mov_b64 exec, 1
    ds_add_u32 v1, v2 offset:72
    s_mov_b64 exec, s[80:81]
L_qk:
    v_and_b32 v3, 15, v0
    v_lshrrev_b32 v4, 4, v0
    v_and_b32 v136, 3, v3
    v_lshlrev_b32 v137, 9, v136
    v_lshl_add_u32 v137, v4, 4, v137
    v_add_u32 v137, 133120, v137
    v_cmp_gt_u32 vcc, 2, v136
    s_nop 0
    s_mov_b64 s[72:73], vcc
    v_and_b32 v138, 3, v3
    v_xor_b32 v138, v138, v4
    v_and_b32 v139, 12, v3
    v_or_b32 v138, v138, v139
    v_lshlrev_b32 v138, 4, v138
    v_lshl_add_u32 v138, v3, 9, v138
    s_sub_u32 s74, s28, 4
    s_lshl_b32 s36, s74, 15
    v_add_u32 v138, s36, v138
    v_xor_b32 v48, 0, v138
    v_xor_b32 v49, 64, v138
    v_xor_b32 v50, 128, v138
    v_xor_b32 v51, 192, v138
    v_xor_b32 v52, 256, v138
    v_xor_b32 v53, 320, v138
    v_xor_b32 v54, 384, v138
    v_xor_b32 v55, 448, v138
    v_mov_b32 v16, 0
    v_mov_b32 v17, 0
    v_mov_b32 v18, 0
    v_mov_b32 v19, 0
    v_mov_b32 v20, 0
    v_mov_b32 v21, 0
    v_mov_b32 v22, 0
    v_mov_b32 v23, 0
    v_mov_b32 v24, 0
    v_mov_b32 v25, 0
    v_mov_b32 v26, 0
    v_mov_b32 v27, 0
    v_mov_b32 v28, 0
    v_mov_b32 v29, 0
    v_mov_b32 v30, 0
    v_mov_b32 v31, 0
    v_mov_b32 v32, 0
    v_mov_b32 v33, 0
    v_mov_b32 v34, 0
    v_mov_b32 v35, 0
    v_mov_b32 v36, 0
    v_mov_b32 v37, 0
    v_mov_b32 v38, 0
    v_mov_b32 v39, 0
    v_mov_b32 v40, 0
    v_mov_b32 v41, 0
    v_mov_b32 v42, 0
    v_mov_b32 v43, 0
    v_mov_b32 v44, 0
    v_mov_b32 v45, 0
    v_mov_b32 v46, 0
    v_mov_b32 v47, 0
    v_mov_b32 v120, 0
    v_mov_b32 v121, 0
    v_mov_b32 v122, 0
    v_mov_b32 v123, 0
    v_mov_b32 v124, 0
    v_mov_b32 v125, 0
    v_mov_b32 v126, 0
    v_mov_b32 v127, 0
    v_mov_b32 v128, 0
    v_mov_b32 v129, 0
    v_mov_b32 v130, 0
    v_mov_b32 v131, 0
    v_mov_b32 v132, 0
    v_mov_b32 v133, 0
    v_mov_b32 v134, 0
    v_mov_b32 v135, 0
    s_lshl_b32 s36, s74, 3
    v_add_u32 v149, s36, v1
    v_and_b32 v146, 7, v3
    v_lshlrev_b32 v146, 4, v146
    s_lshl_b32 s36, s74, 2
    v_add3_u32 v146, v146, s36, v4
    v_lshrrev_b32 v147, 3, v3
    v_lshl_add_u32 v146, v146, 1, v147
    v_lshlrev_b32 v146, 1, v146
    v_add_u32 v146, 134144, v146
    v_cmp_eq_u32 s[36:37], 1, v4
    v_cmp_eq_u32 s[38:39], 2, v4
    v_cmp_eq_u32 s[40:41], 3, v4
    s_mov_b32 s46, 0
L_lw8:
    ds_read_b32 v139, v1 offset:72
    s_add_u32 s46, s46, 1
    s_waitcnt lgkmcnt(0)
    v_readfirstlane_b32 s47, v139
    s_nop 0
    s_cmp_ge_u32 s47, 1
    s_cbranch_scc1 L_lw8_d
    s_sleep 1
    s_cmp_lt_u32 s46, 0x400000
    s_cbranch_scc1 L_lw8
L_lw8_d:
    s_mov_b64 exec, s[72:73]
    ds_read_b128 v[16:19], v137 offset:0
    ds_read_b128 v[20:23], v137 offset:64
    ds_read_b128 v[24:27], v137 offset:128
    ds_read_b128 v[28:31], v137 offset:192
    ds_read_b128 v[32:35], v137 offset:256
    ds_read_b128 v[36:39], v137 offset:320
    ds_read_b128 v[40:43], v137 offset:384
    ds_read_b128 v[44:47], v137 offset:448
    s_mov_b64 exec, -1
    s_mov_b32 s46, 0
L_lw9:
    ds_read_b32 v139, v1 offset:64
    s_add_u32 s46, s46, 1
    s_waitcnt lgkmcnt(0)
    v_readfirstlane_b32 s47, v139
    s_nop 0
    s_cmp_ge_u32 s47, 4
    s_cbranch_scc1 L_lw9_d
    s_sleep 1
    s_cmp_lt_u32 s46, 0x400000
    s_cbranch_scc1 L_lw9
L_lw9_d:
    ds_read_b128 v[56:59], v48 offset:0
    ds_read_b128 v[60:63], v49 offset:0
    ds_read_b128 v[64:67], v50 offset:0
    ds_read_b128 v[68:71], v51 offset:0
    ds_read_b128 v[72:75], v52 offset:0
    ds_read_b128 v[76:79], v53 offset:0
    ds_read_b128 v[80:83], v54 offset:0
    ds_read_b128 v[84:87], v55 offset:0
    ds_read_b128 v[88:91], v48 offset:8192
    ds_read_b128 v[92:95], v49 offset:8192
    ds_read_b128 v[96:99], v50 offset:8192
    ds_read_b128 v[100:103], v51 offset:8192
    ds_read_b128 v[104:107], v52 offset:8192
    ds_read_b128 v[108:111], v53 offset:8192
    ds_read_b128 v[112:115], v54 offset:8192
    ds_read_b128 v[116:119], v55 offset:8192
    s_waitcnt lgkmcnt(8)
    v_mfma_f32_16x16x32_bf16 v[120:123], v[16:19], v[56:59], v[120:123]
    v_mfma_f32_16x16x32_bf16 v[120:123], v[20:23], v[60:63], v[120:123]
    v_mfma_f32_16x16x32_bf16 v[120:123], v[24:27], v[64:67], v[120:123]
    v_mfma_f32_16x16x32_bf16 v[120:123], v[28:31], v[68:71], v[120:123]
    v_mfma_f32_16x16x32_bf16 v[120:123], v[32:35], v[72:75], v[120:123]
    v_mfma_f32_16x16x32_bf16 v[120:123], v[36:39], v[76:79], v[120:123]
    v_mfma_f32_16x16x32_bf16 v[120:123], v[40:43], v[80:83], v[120:123]
    v_mfma_f32_16x16x32_bf16 v[120:123], v[44:47], v[84:87], v[120:123]
    ds_read_b128 v[56:59], v48 offset:16384
    ds_read_b128 v[60:63], v49 offset:16384
    ds_read_b128 v[64:67], v50 offset:16384
    ds_read_b128 v[68:71], v51 offset:16384
    ds_read_b128 v[72:75], v52 offset:16384
    ds_read_b128 v[76:79], v53 offset:16384
    ds_read_b128 v[80:83], v54 offset:16384
    ds_read_b128 v[84:87], v55 offset:16384
    s_waitcnt lgkmcnt(8)
    v_mfma_f32_16x16x32_bf16 v[124:127], v[16:19], v[88:91], v[124:127]
    v_mfma_f32_16x16x32_bf16 v[124:127], v[20:23], v[92:95], v[124:127]
    v_mfma_f32_16x16x32_bf16 v[124:127], v[24:27], v[96:99], v[124:127]
    v_mfma_f32_16x16x32_bf16 v[124:127], v[28:31], v[100:103], v[124:127]
    v_mfma_f32_16x16x32_bf16 v[124:127], v[32:35], v[104:107], v[124:127]
    v_mfma_f32_16x16x32_bf16 v[124:127], v[36:39], v[108:111], v[124:127]
    v_mfma_f32_16x16x32_bf16 v[124:127], v[40:43], v[112:115], v[124:127]
    v_mfma_f32_16x16x32_bf16 v[124:127], v[44:47], v[116:119], v[124:127]
    ds_read_b128 v[88:91], v48 offset:24576
    ds_read_b128 v[92:95], v49 offset:24576
    ds_read_b128 v[96:99], v50 offset:24576
    ds_read_b128 v[100:103], v51 offset:24576
    ds_read_b128 v[104:107], v52 offset:24576
    ds_read_b128 v[108:111], v53 offset:24576
    ds_read_b128 v[112:115], v54 offset:24576
    ds_read_b128 v[116:119], v55 offset:24576
    s_waitcnt lgkmcnt(8)
    v_mfma_f32_16x16x32_bf16 v[128:131], v[16:19], v[56:59], v[128:131]
    v_mfma_f32_16x16x32_bf16 v[128:131], v[20:23], v[60:63], v[128:131]
    v_mfma_f32_16x16x32_bf16 v[128:131], v[24:27], v[64:67], v[128:131]
    v_mfma_f32_16x16x32_bf16 v[128:131], v[28:31], v[68:71], v[128:131]
    v_mfma_f32_16x16x32_bf16 v[128:131], v[32:35], v[72:75], v[128:131]
    v_mfma_f32_16x16x32_bf16 v[128:131], v[36:39], v[76:79], v[128:131]
    v_mfma_f32_16x16x32_bf16 v[128:131], v[40:43], v[80:83], v[128:131]
    v_mfma_f32_16x16x32_bf16 v[128:131], v[44:47], v[84:87], v[128:131]
    s_waitcnt lgkmcnt(0)
    v_mfma_f32_16x16x32_bf16 v[132:135], v[16:19], v[88:91], v[132:135]
    v_mfma_f32_16x16x32_bf16 v[132:135], v[20:23], v[92:95], v[132:135]
    v_mfma_f32_16x16x32_bf16 v[132:135], v[24:27], v[96:99], v[132:135]
    v_mfma_f32_16x16x32_bf16 v[132:135], v[28:31], v[100:103], v[132:135]
    v_mfma_f32_16x16x32_bf16 v[132:135], v[32:35], v[104:107], v[132:135]
    v_mfma_f32_16x16x32_bf16 v[132:135], v[36:39], v[108:111], v[132:135]
    v_mfma_f32_16x16x32_bf16 v[132:135], v[40:43], v[112:115], v[132:135]
    v_mfma_f32_16x16x32_bf16 v[132:135], v[44:47], v[116:119], v[132:135]
    v_cndmask_b32 v140, v120, v124, s[36:37]
    v_cndmask_b32 v140, v140, v128, s[38:39]
    s_nop 5
    v_cndmask_b32 v140, v140, v132, s[40:41]
    v_cndmask_b32 v141, v121, v125, s[36:37]
    v_cndmask_b32 v141, v141, v129, s[38:39]
    v_cndmask_b32 v141, v141, v133, s[40:41]
    v_cvt_pk_bf16_f32 v142, v140, v141
    v_lshlrev_b32 v140, 16, v142
    v_and_b32 v141, 0xffff0000, v142
    v_mul_f32 v140, 0x3d800000, v140
    v_mul_f32 v141, 0x3d800000, v141
    v_mov_b32 v144, v140
    v_mov_b32 v145, v141
    s_nop 0
    v_max_f32_dpp v144, v144, v144 quad_perm:[1,0,3,2] row_mask:0xf bank_mask:0xf
    v_max_f32_dpp v145, v145, v145 quad_perm:[1,0,3,2] row_mask:0xf bank_mask:0xf
    s_nop 0
    v_max_f32_dpp v144, v144, v144 quad_perm:[2,3,0,1] row_mask:0xf bank_mask:0xf
    v_max_f32_dpp v145, v145, v145 quad_perm:[2,3,0,1] row_mask:0xf bank_mask:0xf
    s_nop 0
    v_max_f32_dpp v144, v144, v144 row_half_mirror row_mask:0xf bank_mask:0xf
    v_max_f32_dpp v145, v145, v145 row_half_mirror row_mask:0xf bank_mask:0xf
    s_nop 0
    v_max_f32_dpp v144, v144, v144 row_mirror row_mask:0xf bank_mask:0xf
    v_max_f32_dpp v145, v145, v145 row_mirror row_mask:0xf bank_mask:0xf
    v_mov_b32 v143, v144
    s_nop 1
    v_permlane16_swap_b32 v144, v143
    v_max_f32 v144, v144, v143
    v_mov_b32 v143, v145
    s_nop 1
    v_permlane16_swap_b32 v145, v143
    v_max_f32 v145, v145, v143
    v_mov_b32 v143, v144
    s_nop 1
    v_permlane32_swap_b32 v144, v143
    v_max_f32 v144, v144, v143
    v_mov_b32 v143, v145
    s_nop 1
    v_permlane32_swap_b32 v145, v143
    v_max_f32 v145, v145, v143
    s_mov_b64 exec, 1
    ds_write_b64 v149, v[144:145] offset:160
    s_waitcnt lgkmcnt(0)
    ds_add_u32 v1, v2 offset:76
    s_mov_b64 exec, -1
    s_mov_b32 s46, 0
L_lw10:
    ds_read_b32 v148, v1 offset:76
    s_add_u32 s46, s46, 1
    s_waitcnt lgkmcnt(0)
    v_readfirstlane_b32 s47, v148
    s_nop 0
    s_cmp_ge_u32 s47, 4
    s_cbranch_scc1 L_lw10_d
    s_cmp_lt_u32 s46, 0x400000
    s_cbranch_scc1 L_lw10
L_lw10_d:
    ds_read_b128 v[56:59], v1 offset:160
    ds_read_b128 v[60:63], v1 offset:176
    s_waitcnt lgkmcnt(0)
    v_max3_f32 v144, v56, v58, v60
    v_max_f32 v144, v144, v62
    v_max3_f32 v145, v57, v59, v61
    v_max_f32 v145, v145, v63
    v_sub_f32 v140, v140, v144
    v_mul_f32 v140, 0x3fb8aa3b, v140
    v_exp_f32 v140, v140
    v_sub_f32 v141, v141, v145
    v_mul_f32 v141, 0x3fb8aa3b, v141
    v_exp_f32 v141, v141
    s_nop 0
    v_cvt_pk_bf16_f32 v147, v140, v141
    ds_write_b16 v146, v147
    ds_write_b16_d16_hi v146, v147 offset:512
    v_add_f32_dpp v140, v140, v140 quad_perm:[1,0,3,2] row_mask:0xf bank_mask:0xf
    v_add_f32_dpp v141, v141, v141 quad_perm:[1,0,3,2] row_mask:0xf bank_mask:0xf
    s_nop 0
    v_add_f32_dpp v140, v140, v140 quad_perm:[2,3,0,1] row_mask:0xf bank_mask:0xf
    v_add_f32_dpp v141, v141, v141 quad_perm:[2,3,0,1] row_mask:0xf bank_mask:0xf
    s_nop 0
    v_add_f32_dpp v140, v140, v140 row_half_mirror row_mask:0xf bank_mask:0xf
    v_add_f32_dpp v141, v141, v141 row_half_mirror row_mask:0xf bank_mask:0xf
    s_nop 0
    v_add_f32_dpp v140, v140, v140 row_mirror row_mask:0xf bank_mask:0xf
    v_add_f32_dpp v141, v141, v141 row_mirror row_mask:0xf bank_mask:0xf
    v_mov_b32 v148, v140
    s_nop 1
    v_permlane16_swap_b32 v140, v148
    v_add_f32 v140, v140, v148
    v_mov_b32 v148, v141
    s_nop 1
    v_permlane16_swap_b32 v141, v148
    v_add_f32 v141, v141, v148
    v_mov_b32 v148, v140
    s_nop 1
    v_permlane32_swap_b32 v140, v148
    v_add_f32 v140, v140, v148
    v_mov_b32 v148, v141
    s_nop 1
    v_permlane32_swap_b32 v141, v148
    v_add_f32 v141, v141, v148
    s_mov_b64 exec, 1
    ds_write_b64 v149, v[140:141] offset:192
    s_waitcnt lgkmcnt(0)
    ds_add_u32 v1, v2 offset:80
    s_mov_b64 exec, -1
    s_cmp_eq_u32 s28, 7
    s_cbranch_scc1 L_w7b
    s_cmp_eq_u32 s28, 6
    s_cbranch_scc1 L_w6b
    s_cmp_eq_u32 s28, 4
    s_cbranch_scc1 L_w4b
    s_cmp_ge_u32 s29, 7
    s_cbranch_scc1 L_w45_end
    s_mov_b32 s46, 0
L_lw11:
    ds_read_b32 v5, v1 offset:224
    s_add_u32 s46, s46, 1
    s_waitcnt lgkmcnt(0)
    v_readfirstlane_b32 s47, v5
    s_nop 0
    s_cmp_ge_u32 s47, 1
    s_cbranch_scc1 L_lw11_d
    s_sleep 1
    s_cmp_lt_u32 s46, 0x400000
    s_cbranch_scc1 L_lw11
L_lw11_d:
    s_sub_u32 s36, s47, 1
    s_cmp_ge_u32 s36, 28
    s_cbranch_scc1 L_w45_end
    s_mul_i32 s67, s36, 37
    s_lshr_b32 s67, s67, 8
    s_mul_i32 s68, s67, 7
    s_sub_u32 s68, s36, s68
    s_lshl_b32 s76, s29, 2
    s_add_u32 s76, s76, s67
    v_lshrrev_b32 v3, 3, v0
    v_mul_u32_u24 v3, 896, v3
    v_and_b32 v4, 7, v0
    v_lshl_add_u32 v3, v4, 4, v3
    s_lshl_b32 s36, s68, 7
    v_add_u32 v3, s36, v3
    s_mul_i32 s76, s76, 57344
    s_mov_b32 s48, s20
    s_mov_b32 s49, s21
    s_mov_b32 s50, 1605632
    s_mov_b32 s51, 0x00020000
    s_mov_b32 s46, 0
L_lw12:
    ds_read_b32 v5, v1 offset:80
    s_add_u32 s46, s46, 1
    s_waitcnt lgkmcnt(0)
    v_readfirstlane_b32 s47, v5
    s_nop 0
    s_cmp_ge_u32 s47, 4
    s_cbranch_scc1 L_lw12_d
    s_sleep 1
    s_cmp_lt_u32 s46, 0x400000
    s_cbranch_scc1 L_lw12
L_lw12_d:
    s_mov_b32 s46, 0
L_lw13:
    ds_read_b32 v5, v1 offset:92
    s_add_u32 s46, s46, 1
    s_waitcnt lgkmcnt(0)
    v_readfirstlane_b32 s47, v5
    s_nop 0
    s_cmp_ge_u32 s47, 4
    s_cbranch_scc1 L_lw13_d
    s_sleep 1
    s_cmp_lt_u32 s46, 0x400000
    s_cbranch_scc1 L_lw13
L_lw13_d:
    s_mov_b32 m0, 16384
    s_add_u32 s77, s76, 0
    buffer_load_dwordx4 v3, s[48:51], s77 offen nt lds
    s_mov_b32 m0, 17408
    s_add_u32 s77, s76, 7168
    buffer_load_dwordx4 v3, s[48:51], s77 offen nt lds
    s_mov_b32 m0, 18432
    s_add_u32 s77, s76, 14336
    buffer_load_dwordx4 v3, s[48:51], s77 offen nt lds
    s_mov_b32 m0, 19456
    s_add_u32 s77, s76, 21504
    buffer_load_dwordx4 v3, s[48:51], s77 offen nt lds
    s_mov_b32 m0, 20480
    s_add_u32 s77, s76, 28672
    buffer_load_dwordx4 v3, s[48:51], s77 offen nt lds
    s_mov_b32 m0, 21504
    s_add_u32 s77, s76, 35840
    buffer_load_dwordx4 v3, s[48:51], s77 offen nt lds
    s_mov_b32 m0, 22528
    s_add_u32 s77, s76, 43008
    buffer_load_dwordx4 v3, s[48:51], s77 offen nt lds
    s_mov_b32 m0, 23552
    s_add_u32 s77, s76, 50176
    buffer_load_dwordx4 v3, s[48:51], s77 offen nt lds
    s_waitcnt vmcnt(0)
    s_mov_b64 s[80:81], exec
    s_mov_b64 exec, 1
    ds_add_u32 v1, v2 offset:124
    s_mov_b64 exec, s[80:81]
    s_branch L_w45_end
L_w4b:
L_w45_end:
    s_endpgm
L_w7:
    v_mov_b32 v32, -1
    v_mov_b32 v33, -1
    v_mov_b32 v34, -1
    v_mov_b32 v35, -1
    v_mov_b32 v6, 0
    s_and_b32 s36, s30, 7
    s_lshr_b32 s37, s30, 3
    s_lshl_b32 s64, s29, 3
    s_add_u32 s64, s64, s37
    s_lshl_b32 s64, s64, 3
    s_add_u32 s64, s64, s36
    s_lshl_b32 s64, s64, 8
    s_add_u32 s64, s64, 65536
    s_lshl_b32 s65, s29, 5
    s_add_u32 s65, s65, s30
    s_lshl_b32 s66, s65, 4
    s_add_u32 s66, s66, 851968
    s_lshl_b32 s71, s65, 7
    s_add_u32 s71, s71, 4096
    s_lshl_b32 s65, s65, 9
    s_add_u32 s65, s65, 196608
    v_and_b32 v12, 15, v0
    v_lshlrev_b32 v12, 4, v12
    v_bfe_u32 v13, v0, 4, 1
    v_lshlrev_b32 v14, 13, v13
    v_add3_u32 v14, v14, v12, s64
    v_lshlrev_b32 v15, 8, v13
    v_add3_u32 v15, v15, v12, s65
    v_cmp_gt_u32 vcc, 32, v0
    s_nop 1
    v_cndmask_b32 v14, v15, v14, vcc
    s_lshl_b32 s64, s29, 7
    s_add_u32 s64, s64, s30
    s_lshl_b32 s64, s64, 9
    s_add_u32 s64, s64, 327680
    v_lshrrev_b32 v16, 5, v0
    v_lshlrev_b32 v16, 14, v16
    v_and_b32 v17, 31, v0
    v_lshl_add_u32 v16, v17, 4, v16
    v_add_u32 v16, s64, v16
    v_add_u32 v18, 32768, v16
    v_mov_b32 v19, s66
    s_mul_i32 s67, s30, 37
    s_lshr_b32 s67, s67, 8
    s_mul_i32 s68, s67, 7
    s_sub_u32 s68, s30, s68
    s_lshl_b32 s69, s68, 3
    s_add_u32 s69, s69, s29
    s_lshl_b32 s69, s69, 2
    s_add_u32 s69, s69, s67
    s_lshl_b32 s69, s69, 9
    s_add_u32 s69, s69, 884736
    s_mul_i32 s70, s68, 28
    s_lshl_b32 s36, s29, 2
    s_add_u32 s70, s70, s36
    s_add_u32 s70, s70, s67
    s_lshl_b32 s70, s70, 9
    s_add_u32 s70, s70, 1015808
    v_lshlrev_b32 v17, 4, v17
    v_add_u32 v8, s69, v17
    v_add_u32 v9, s70, v17
    v_cndmask_b32 v8, v9, v8, vcc
    s_waitcnt lgkmcnt(0)
    global_load_dwordx2 v[10:11], v6, s[26:27] sc1
    global_store_dwordx4 v14, v[32:35], s[26:27] sc1
    s_mov_b64 exec, 1
    s_cmp_lg_u32 s30, 0
    s_cbranch_scc1 L_notk
    s_lshl_b32 s36, s29, 7
    s_add_u32 s36, s36, 1204224
    v_mov_b32 v40, s36
    global_store_dword v40, v6, s[26:27] sc1
L_notk:
    global_store_dwordx4 v19, v[32:35], s[26:27] sc1
    s_mov_b64 exec, -1
    s_cmp_ge_u32 s30, 28
    s_cbranch_scc1 L_clr_done
    s_cmp_lt_u32 s29, 7
    s_cselect_b32 exec_hi, -1, 0
    global_store_dwordx4 v8, v[32:35], s[26:27] sc1
    s_mov_b64 exec, -1
L_clr_done:
    s_barrier
    s_waitcnt vmcnt(0)
    v_readfirstlane_b32 s36, v10
    v_readfirstlane_b32 s37, v11
    s_add_u32 s72, s36, 1
    s_addc_u32 s73, s37, 0
    s_lshl_b64 s[84:85], s[72:73], 4
    s_getreg_b32 s38, hwreg(HW_REG_XCC_ID, 0, 4)
    s_or_b32 s38, s38, s84
    v_mov_b32 v6, s38
    v_mov_b32 v7, s85
    v_mov_b32 v8, s71
    v_add_u32 v9, 1142784, v8
    v_mov_b32 v10, s84
    v_mov_b32 v11, s85
    v_mov_b32 v12, s72
    v_mov_b32 v13, s73
    v_lshl_add_u32 v9, v0, 4, v9
    v_mov_b32 v32, v6
    v_mov_b32 v33, v7
    s_mov_b64 exec, 0xff
    global_store_dwordx4 v9, v[32:35], s[26:27]
    s_mov_b64 exec, 1
    global_store_dwordx2 v8, v[6:7], s[26:27] sc1
    ds_write_b64 v1, v[10:11] offset:128
    ds_write_b64 v1, v[12:13] offset:136
    s_waitcnt lgkmcnt(0)
    ds_add_u32 v1, v2 offset:68
    s_mov_b64 exec, -1
    s_mov_b32 s46, 0
L_lw14:
    ds_read_b32 v10, v1 offset:88
    s_add_u32 s46, s46, 1
    s_waitcnt lgkmcnt(0)
    v_readfirstlane_b32 s47, v10
    s_nop 0
    s_cmp_ge_u32 s47, 1
    s_cbranch_scc1 L_lw14_d
    s_sleep 1
    s_cmp_lt_u32 s46, 0x400000
    s_cbranch_scc1 L_lw14
L_lw14_d:
    v_mov_b32 v32, -1
    v_mov_b32 v33, -1
    ds_read_b32 v10, v1 offset:108
    s_waitcnt lgkmcnt(0)
    v_readfirstlane_b32 s79, v10
    s_nop 0
    s_cmp_eq_u32 s79, 2
    s_cbranch_scc1 L_opc_f
    global_store_dwordx4 v16, v[32:35], s[26:27] sc1
    global_store_dwordx4 v18, v[32:35], s[26:27] sc1
    s_branch L_opc_d
L_opc_f:
    global_store_dwordx4 v16, v[32:35], s[26:27]
    global_store_dwordx4 v18, v[32:35], s[26:27]
L_opc_d:
    s_waitcnt vmcnt(0)
    s_mov_b64 s[80:81], exec
    s_mov_b64 exec, 1
    ds_add_u32 v1, v2 offset:120
    s_mov_b64 exec, s[80:81]
    s_branch L_qk
L_w7b:
    s_mov_b32 s46, 0
L_lw15:
    ds_read_b32 v6, v1 offset:80
    s_add_u32 s46, s46, 1
    s_waitcnt lgkmcnt(0)
    v_readfirstlane_b32 s47, v6
    s_nop 0
    s_cmp_ge_u32 s47, 4
    s_cbranch_scc1 L_lw15_d
    s_sleep 1
    s_cmp_lt_u32 s46, 0x400000
    s_cbranch_scc1 L_lw15
L_lw15_d:
    ds_read_b32 v6, v1 offset:108
    s_waitcnt lgkmcnt(0)
    v_readfirstlane_b32 s79, v6
    ds_read_b128 v[208:211], v1 offset:160
    ds_read_b128 v[212:215], v1 offset:176
    ds_read_b128 v[216:219], v1 offset:192
    ds_read_b128 v[220:223], v1 offset:208
    s_waitcnt lgkmcnt(0)
    v_max3_f32 v6, v208, v210, v212
    v_max_f32 v6, v6, v214
    v_add_f32 v7, v216, v218
    v_add_f32 v10, v220, v222
    v_add_f32 v7, v7, v10
    v_max3_f32 v8, v209, v211, v213
    v_max_f32 v8, v8, v215
    v_add_f32 v9, v217, v219
    v_add_f32 v10, v221, v223
    v_add_f32 v9, v9, v10
    v_min_u32 v6, -2, v6
    v_min_u32 v7, -2, v7
    v_min_u32 v8, -2, v8
    v_min_u32 v9, -2, v9
    v_mov_b32 v10, s66
    s_mov_b64 exec, 1
    s_cmp_eq_u32 s79, 2
    s_cbranch_scc1 L_mlst_f
    global_store_dwordx4 v10, v[6:9], s[26:27] sc1
    s_branch L_mlst_d
L_mlst_f:
    global_store_dwordx4 v10, v[6:9], s[26:27]
L_mlst_d:
    s_mov_b64 exec, -1
    s_mov_b32 s46, 0
L_lw16:
    ds_read_b32 v6, v1 offset:224
    s_add_u32 s46, s46, 1
    s_waitcnt lgkmcnt(0)
    v_readfirstlane_b32 s47, v6
    s_nop 0
    s_cmp_ge_u32 s47, 1
    s_cbranch_scc1 L_lw16_d
    s_sleep 1
    s_cmp_lt_u32 s46, 0x400000
    s_cbranch_scc1 L_lw16
L_lw16_d:
    s_sub_u32 s36, s47, 1
    s_cmp_ge_u32 s36, 28
    s_cbranch_scc1 L_w7_end
    s_mul_i32 s67, s36, 37
    s_lshr_b32 s67, s67, 8
    s_mul_i32 s68, s67, 7
    s_sub_u32 s68, s36, s68
    s_lshl_b32 s69, s68, 3
    s_add_u32 s69, s69, s29
    s_lshl_b32 s69, s69, 2
    s_add_u32 s69, s69, s67
    s_lshl_b32 s69, s69, 9
    s_add_u32 s69, s69, 884736
    v_and_b32 v3, 15, v0
    v_lshrrev_b32 v4, 4, v0
    v_lshlrev_b32 v5, 3, v4
    v_mul_u32_u24 v5, 896, v5
    v_lshl_add_u32 v5, v3, 3, v5
    s_lshl_b32 s36, s68, 7
    v_add_u32 v5, s36, v5
    s_lshl_b32 s76, s29, 2
    s_add_u32 s76, s76, s67
    s_mul_i32 s76, s76, 114688
    s_mov_b32 s48, s12
    s_mov_b32 s49, s13
    s_mov_b32 s50, 3670016
    s_mov_b32 s51, 0x00020000
    s_mov_b32 s46, 0
L_lw17:
    ds_read_b32 v6, v1 offset:92
    s_add_u32 s46, s46, 1
    s_waitcnt lgkmcnt(0)
    v_readfirstlane_b32 s47, v6
    s_nop 0
    s_cmp_ge_u32 s47, 4
    s_cbranch_scc1 L_lw17_d
    s_sleep 1
    s_cmp_lt_u32 s46, 0x400000
    s_cbranch_scc1 L_lw17
L_lw17_d:
    s_add_u32 s77, s76, 0
    buffer_load_dwordx2 v[32:33], v5, s[48:51], s77 offen nt
    s_add_u32 s77, s76, 896
    buffer_load_dwordx2 v[34:35], v5, s[48:51], s77 offen nt
    s_add_u32 s77, s76, 1792
    buffer_load_dwordx2 v[36:37], v5, s[48:51], s77 offen nt
    s_add_u32 s77, s76, 2688
    buffer_load_dwordx2 v[38:39], v5, s[48:51], s77 offen nt
    s_add_u32 s77, s76, 3584
    buffer_load_dwordx2 v[40:41], v5, s[48:51], s77 offen nt
    s_add_u32 s77, s76, 4480
    buffer_load_dwordx2 v[42:43], v5, s[48:51], s77 offen nt
    s_add_u32 s77, s76, 5376
    buffer_load_dwordx2 v[44:45], v5, s[48:51], s77 offen nt
    s_add_u32 s77, s76, 6272
    buffer_load_dwordx2 v[46:47], v5, s[48:51], s77 offen nt
    s_add_u32 s77, s76, 28672
    buffer_load_dwordx2 v[48:49], v5, s[48:51], s77 offen nt
    s_add_u32 s77, s76, 29568
    buffer_load_dwordx2 v[50:51], v5, s[48:51], s77 offen nt
    s_add_u32 s77, s76, 30464
    buffer_load_dwordx2 v[52:53], v5, s[48:51], s77 offen nt
    s_add_u32 s77, s76, 31360
    buffer_load_dwordx2 v[54:55], v5, s[48:51], s77 offen nt
    s_add_u32 s77, s76, 32256
    buffer_load_dwordx2 v[56:57], v5, s[48:51], s77 offen nt
    s_add_u32 s77, s76, 33152
    buffer_load_dwordx2 v[58:59], v5, s[48:51], s77 offen nt
    s_add_u32 s77, s76, 34048
    buffer_load_dwordx2 v[60:61], v5, s[48:51], s77 offen nt
    s_add_u32 s77, s76, 34944
    buffer_load_dwordx2 v[62:63], v5, s[48:51], s77 offen nt
    s_add_u32 s77, s76, 57344
    buffer_load_dwordx2 v[64:65], v5, s[48:51], s77 offen nt
    s_add_u32 s77, s76, 58240
    buffer_load_dwordx2 v[66:67], v5, s[48:51], s77 offen nt
    s_add_u32 s77, s76, 59136
    buffer_load_dwordx2 v[68:69], v5, s[48:51], s77 offen nt
    s_add_u32 s77, s76, 60032
    buffer_load_dwordx2 v[70:71], v5, s[48:51], s77 offen nt
    s_add_u32 s77, s76, 60928
    buffer_load_dwordx2 v[72:73], v5, s[48:51], s77 offen nt
    s_add_u32 s77, s76, 61824
    buffer_load_dwordx2 v[74:75], v5, s[48:51], s77 offen nt
    s_add_u32 s77, s76, 62720
    buffer_load_dwordx2 v[76:77], v5, s[48:51], s77 offen nt
    s_add_u32 s77, s76, 63616
    buffer_load_dwordx2 v[78:79], v5, s[48:51], s77 offen nt
    s_add_u32 s77, s76, 86016
    buffer_load_dwordx2 v[80:81], v5, s[48:51], s77 offen nt
    s_add_u32 s77, s76, 86912
    buffer_load_dwordx2 v[82:83], v5, s[48:51], s77 offen nt
    s_add_u32 s77, s76, 87808
    buffer_load_dwordx2 v[84:85], v5, s[48:51], s77 offen nt
    s_add_u32 s77, s76, 88704
    buffer_load_dwordx2 v[86:87], v5, s[48:51], s77 offen nt
    s_add_u32 s77, s76, 89600
    buffer_load_dwordx2 v[88:89], v5, s[48:51], s77 offen nt
    s_add_u32 s77, s76, 90496
    buffer_load_dwordx2 v[90:91], v5, s[48:51], s77 offen nt
    s_add_u32 s77, s76, 91392
    buffer_load_dwordx2 v[92:93], v5, s[48:51], s77 offen nt
    s_add_u32 s77, s76, 92288
    buffer_load_dwordx2 v[94:95], v5, s[48:51], s77 offen nt
    s_lshl_b32 s36, s29, 2
    s_add_u32 s36, s36, s67
    s_lshl_b32 s36, s36, 14
    s_add_u32 s36, s36, 327680
    v_lshrrev_b32 v6, 5, v0
    v_lshlrev_b32 v6, 13, v6
    v_and_b32 v7, 31, v0
    v_lshl_add_u32 v6, v7, 4, v6
    v_add_u32 v6, s36, v6
    v_add_u32 v7, 4096, v6
    v_lshlrev_b32 v8, 8, v3
    v_lshl_add_u32 v8, v4, 4, v8
    v_add_u32 v8, 135424, v8
    v_lshrrev_b32 v9, 5, v0
    v_lshlrev_b32 v9, 8, v9
    v_and_b32 v10, 31, v0
    v_lshl_add_u32 v9, v10, 3, v9
    v_add_u32 v9, 135424, v9
    v_mov_b32 v176, 0
    v_mov_b32 v177, 0
    v_mov_b32 v178, 0
    v_mov_b32 v179, 0
    v_mov_b32 v180, 0
    v_mov_b32 v181, 0
    v_mov_b32 v182, 0
    v_mov_b32 v183, 0
    v_mov_b32 v184, 0
    v_mov_b32 v185, 0
    v_mov_b32 v186, 0
    v_mov_b32 v187, 0
    v_mov_b32 v188, 0
    v_mov_b32 v189, 0
    v_mov_b32 v190, 0
    v_mov_b32 v191, 0
    v_mov_b32 v192, 0
    v_mov_b32 v193, 0
    v_mov_b32 v194, 0
    v_mov_b32 v195, 0
    v_mov_b32 v196, 0
    v_mov_b32 v197, 0
    v_mov_b32 v198, 0
    v_mov_b32 v199, 0
    v_mov_b32 v200, 0
    v_mov_b32 v201, 0
    v_mov_b32 v202, 0
    v_mov_b32 v203, 0
    v_mov_b32 v204, 0
    v_mov_b32 v205, 0
    v_mov_b32 v206, 0
    v_mov_b32 v207, 0
    v_cmp_gt_u32 s[74:75], 2, v3
    v_lshlrev_b32 v11, 4, v3
    v_add_u32 v11, s69, v11
    v_and_b32 v224, 31, v0
    v_lshlrev_b32 v225, 2, v224
    v_add_u32 v225, v1, v225
    v_lshlrev_b32 v224, 4, v224
    s_lshl_b32 s36, s29, 9
    s_lshr_b32 s37, s67, 1
    s_lshl_b32 s37, s37, 3
    s_add_u32 s36, s36, s37
    s_add_u32 s36, s36, 851968
    v_add_u32 v224, s36, v224
    v_lshrrev_b32 v234, 5, v0
    v_lshl_add_u32 v234, v234, 6, v1
    s_mov_b32 s82, 0
    global_load_dwordx2 v[226:227], v224, s[26:27] sc1
    s_waitcnt vmcnt(25)
    v_perm_b32 v16, v34, v32, s33
    v_perm_b32 v20, v34, v32, s34
    v_perm_b32 v24, v35, v33, s33
    v_perm_b32 v28, v35, v33, s34
    v_perm_b32 v17, v38, v36, s33
    v_perm_b32 v21, v38, v36, s34
    v_perm_b32 v25, v39, v37, s33
    v_perm_b32 v29, v39, v37, s34
    v_perm_b32 v18, v42, v40, s33
    v_perm_b32 v22, v42, v40, s34
    v_perm_b32 v26, v43, v41, s33
    v_perm_b32 v30, v43, v41, s34
    v_perm_b32 v19, v46, v44, s33
    v_perm_b32 v23, v46, v44, s34
    v_perm_b32 v27, v47, v45, s33
    v_perm_b32 v31, v47, v45, s34
    s_waitcnt vmcnt(17)
    v_perm_b32 v32, v50, v48, s33
    v_perm_b32 v36, v50, v48, s34
    v_perm_b32 v40, v51, v49, s33
    v_perm_b32 v44, v51, v49, s34
    v_perm_b32 v33, v54, v52, s33
    v_perm_b32 v37, v54, v52, s34
    v_perm_b32 v41, v55, v53, s33
    v_perm_b32 v45, v55, v53, s34
    v_perm_b32 v34, v58, v56, s33
    v_perm_b32 v38, v58, v56, s34
    v_perm_b32 v42, v59, v57, s33
    v_perm_b32 v46, v59, v57, s34
    v_perm_b32 v35, v62, v60, s33
    v_perm_b32 v39, v62, v60, s34
    v_perm_b32 v43, v63, v61, s33
    v_perm_b32 v47, v63, v61, s34
    s_waitcnt vmcnt(9)
    v_perm_b32 v48, v66, v64, s33
    v_perm_b32 v52, v66, v64, s34
    v_perm_b32 v56, v67, v65, s33
    v_perm_b32 v60, v67, v65, s34
    v_perm_b32 v49, v70, v68, s33
    v_perm_b32 v53, v70, v68, s34
    v_perm_b32 v57, v71, v69, s33
    v_perm_b32 v61, v71, v69, s34
    v_perm_b32 v50, v74, v72, s33
    v_perm_b32 v54, v74, v72, s34
    v_perm_b32 v58, v75, v73, s33
    v_perm_b32 v62, v75, v73, s34
    v_perm_b32 v51, v78, v76, s33
    v_perm_b32 v55, v78, v76, s34
    v_perm_b32 v59, v79, v77, s33
    v_perm_b32 v63, v79, v77, s34
    s_waitcnt vmcnt(1)
    v_perm_b32 v64, v82, v80, s33
    v_perm_b32 v68, v82, v80, s34
    v_perm_b32 v72, v83, v81, s33
    v_perm_b32 v76, v83, v81, s34
    v_perm_b32 v65, v86, v84, s33
    v_perm_b32 v69, v86, v84, s34
    v_perm_b32 v73, v87, v85, s33
    v_perm_b32 v77, v87, v85, s34
    v_perm_b32 v66, v90, v88, s33
    v_perm_b32 v70, v90, v88, s34
    v_perm_b32 v74, v91, v89, s33
    v_perm_b32 v78, v91, v89, s34
    v_perm_b32 v67, v94, v92, s33
    v_perm_b32 v71, v94, v92, s34
    v_perm_b32 v75, v95, v93, s33
    v_perm_b32 v79, v95, v93, s34
    s_waitcnt vmcnt(0)
L_mlc:
    v_max_u32 v228, v226, v227
    v_cmp_eq_u32 vcc, -1, v228
    s_nop 0
    s_cmp_eq_u64 vcc, 0
    s_cbranch_scc1 L_mlc_d
    s_add_u32 s82, s82, 1
    s_sleep 2
    global_load_dwordx2 v[226:227], v224, s[26:27] sc1
    s_waitcnt vmcnt(0)
    s_cmp_lt_u32 s82, 65536
    s_cbranch_scc1 L_mlc
L_mlc_d:
    v_mov_b32 v228, v226
    s_nop 1
    v_max_f32_dpp v228, v228, v228 quad_perm:[1,0,3,2] row_mask:0xf bank_mask:0xf
    s_nop 1
    v_max_f32_dpp v228, v228, v228 quad_perm:[2,3,0,1] row_mask:0xf bank_mask:0xf
    s_nop 1
    v_max_f32_dpp v228, v228, v228 row_half_mirror row_mask:0xf bank_mask:0xf
    s_nop 1
    v_max_f32_dpp v228, v228, v228 row_mirror row_mask:0xf bank_mask:0xf
    v_sub_f32 v229, v226, v228
    v_mul_f32 v229, 0x3fb8aa3b, v229
    v_exp_f32 v229, v229
    s_nop 0
    v_mul_f32 v230, v229, v227
    s_nop 1
    v_add_f32_dpp v230, v230, v230 quad_perm:[1,0,3,2] row_mask:0xf bank_mask:0xf
    s_nop 1
    v_add_f32_dpp v230, v230, v230 quad_perm:[2,3,0,1] row_mask:0xf bank_mask:0xf
    s_nop 1
    v_add_f32_dpp v230, v230, v230 row_half_mirror row_mask:0xf bank_mask:0xf
    s_nop 1
    v_add_f32_dpp v230, v230, v230 row_mirror row_mask:0xf bank_mask:0xf
    v_rcp_f32 v231, v230
    s_nop 0
    v_mul_f32 v232, v229, v231
    v_fma_f32 v233, -v232, v230, v229
    v_fma_f32 v232, v233, v231, v232
    ds_write_b32 v225, v232 offset:4864
    ds_read_b128 v[96:99], v234 offset:4864
    ds_read_b128 v[100:103], v234 offset:4880
    ds_read_b128 v[104:107], v234 offset:4896
    ds_read_b128 v[108:111], v234 offset:4912
    s_waitcnt lgkmcnt(0)
    s_mov_b32 s82, 0
    s_mov_b32 s46, 0
L_lw18:
    ds_read_b32 v216, v1 offset:96
    s_add_u32 s46, s46, 1
    s_waitcnt lgkmcnt(0)
    v_readfirstlane_b32 s47, v216
    s_nop 0
    s_cmp_ge_u32 s47, 4
    s_cbranch_scc1 L_lw18_d
    s_cmp_lt_u32 s46, 0x400000
    s_cbranch_scc1 L_lw18
L_lw18_d:
L_og:
    global_load_dwordx4 v[112:115], v6, s[26:27] offset:0 sc1
    global_load_dwordx4 v[116:119], v6, s[26:27] offset:512 sc1
    global_load_dwordx4 v[120:123], v6, s[26:27] offset:1024 sc1
    global_load_dwordx4 v[124:127], v6, s[26:27] offset:1536 sc1
    global_load_dwordx4 v[128:131], v6, s[26:27] offset:2048 sc1
    global_load_dwordx4 v[132:135], v6, s[26:27] offset:2560 sc1
    global_load_dwordx4 v[136:139], v6, s[26:27] offset:3072 sc1
    global_load_dwordx4 v[140:143], v6, s[26:27] offset:3584 sc1
    global_load_dwordx4 v[144:147], v7, s[26:27] offset:0 sc1
    global_load_dwordx4 v[148:151], v7, s[26:27] offset:512 sc1
    global_load_dwordx4 v[152:155], v7, s[26:27] offset:1024 sc1
    global_load_dwordx4 v[156:159], v7, s[26:27] offset:1536 sc1
    global_load_dwordx4 v[160:163], v7, s[26:27] offset:2048 sc1
    global_load_dwordx4 v[164:167], v7, s[26:27] offset:2560 sc1
    global_load_dwordx4 v[168:171], v7, s[26:27] offset:3072 sc1
    global_load_dwordx4 v[172:175], v7, s[26:27] offset:3584 sc1
L_og1:
    s_add_u32 s82, s82, 1
    s_waitcnt vmcnt(15)
    v_pk_mul_f32 v[208:209], v[112:113], v[96:97] op_sel_hi:[1,0]
    v_pk_mul_f32 v[210:211], v[114:115], v[96:97] op_sel_hi:[1,0]
    s_waitcnt vmcnt(14)
    v_pk_fma_f32 v[208:209], v[116:117], v[96:97], v[208:209] op_sel:[0,1,0] op_sel_hi:[1,1,1]
    v_pk_fma_f32 v[210:211], v[118:119], v[96:97], v[210:211] op_sel:[0,1,0] op_sel_hi:[1,1,1]
    s_waitcnt vmcnt(13)
    v_pk_fma_f32 v[208:209], v[120:121], v[98:99], v[208:209] op_sel_hi:[1,0,1]
    v_pk_fma_f32 v[210:211], v[122:123], v[98:99], v[210:211] op_sel_hi:[1,0,1]
    s_waitcnt vmcnt(12)
    v_pk_fma_f32 v[208:209], v[124:125], v[98:99], v[208:209] op_sel:[0,1,0] op_sel_hi:[1,1,1]
    v_pk_fma_f32 v[210:211], v[126:127], v[98:99], v[210:211] op_sel:[0,1,0] op_sel_hi:[1,1,1]
    s_waitcnt vmcnt(11)
    v_pk_fma_f32 v[208:209], v[128:129], v[100:101], v[208:209] op_sel_hi:[1,0,1]
    v_pk_fma_f32 v[210:211], v[130:131], v[100:101], v[210:211] op_sel_hi:[1,0,1]
    s_waitcnt vmcnt(10)
    v_pk_fma_f32 v[208:209], v[132:133], v[100:101], v[208:209] op_sel:[0,1,0] op_sel_hi:[1,1,1]
    v_pk_fma_f32 v[210:211], v[134:135], v[100:101], v[210:211] op_sel:[0,1,0] op_sel_hi:[1,1,1]
    s_waitcnt vmcnt(9)
    v_pk_fma_f32 v[208:209], v[136:137], v[102:103], v[208:209] op_sel_hi:[1,0,1]
    v_pk_fma_f32 v[210:211], v[138:139], v[102:103], v[210:211] op_sel_hi:[1,0,1]
    s_waitcnt vmcnt(8)
    v_pk_fma_f32 v[208:209], v[140:141], v[102:103], v[208:209] op_sel:[0,1,0] op_sel_hi:[1,1,1]
    v_pk_fma_f32 v[210:211], v[142:143], v[102:103], v[210:211] op_sel:[0,1,0] op_sel_hi:[1,1,1]
    s_waitcnt vmcnt(7)
    v_pk_fma_f32 v[208:209], v[144:145], v[104:105], v[208:209] op_sel_hi:[1,0,1]
    v_pk_fma_f32 v[210:211], v[146:147], v[104:105], v[210:211] op_sel_hi:[1,0,1]
    s_waitcnt vmcnt(6)
    v_pk_fma_f32 v[208:209], v[148:149], v[104:105], v[208:209] op_sel:[0,1,0] op_sel_hi:[1,1,1]
    v_pk_fma_f32 v[210:211], v[150:151], v[104:105], v[210:211] op_sel:[0,1,0] op_sel_hi:[1,1,1]
    s_waitcnt vmcnt(5)
    v_pk_fma_f32 v[208:209], v[152:153], v[106:107], v[208:209] op_sel_hi:[1,0,1]
    v_pk_fma_f32 v[210:211], v[154:155], v[106:107], v[210:211] op_sel_hi:[1,0,1]
    s_waitcnt vmcnt(4)
    v_pk_fma_f32 v[208:209], v[156:157], v[106:107], v[208:209] op_sel:[0,1,0] op_sel_hi:[1,1,1]
    v_pk_fma_f32 v[210:211], v[158:159], v[106:107], v[210:211] op_sel:[0,1,0] op_sel_hi:[1,1,1]
    s_waitcnt vmcnt(3)
    v_pk_fma_f32 v[208:209], v[160:161], v[108:109], v[208:209] op_sel_hi:[1,0,1]
    v_pk_fma_f32 v[210:211], v[162:163], v[108:109], v[210:211] op_sel_hi:[1,0,1]
    s_waitcnt vmcnt(2)
    v_pk_fma_f32 v[208:209], v[164:165], v[108:109], v[208:209] op_sel:[0,1,0] op_sel_hi:[1,1,1]
    v_pk_fma_f32 v[210:211], v[166:167], v[108:109], v[210:211] op_sel:[0,1,0] op_sel_hi:[1,1,1]
    s_waitcnt vmcnt(1)
    v_pk_fma_f32 v[208:209], v[168:169], v[110:111], v[208:209] op_sel_hi:[1,0,1]
    v_pk_fma_f32 v[210:211], v[170:171], v[110:111], v[210:211] op_sel_hi:[1,0,1]
    s_waitcnt vmcnt(0)
    v_pk_fma_f32 v[208:209], v[172:173], v[110:111], v[208:209] op_sel:[0,1,0] op_sel_hi:[1,1,1]
    v_pk_fma_f32 v[210:211], v[174:175], v[110:111], v[210:211] op_sel:[0,1,0] op_sel_hi:[1,1,1]
    v_add_f32 v212, v208, v209
    v_add_f32 v213, v210, v211
    v_cmp_u_f32 vcc, v212, v213
    s_nop 0
    s_cmp_eq_u64 vcc, 0
    s_cbranch_scc1 L_og_d
    s_and_b32 s45, s82, 31
    s_cbranch_scc1 L_og
    v_max3_u32 v214, v112, v113, v114
    v_max3_u32 v214, v214, v115, v116
    v_max3_u32 v214, v214, v117, v118
    v_max3_u32 v214, v214, v119, v120
    v_max3_u32 v214, v214, v121, v122
    v_max3_u32 v214, v214, v123, v124
    v_max3_u32 v214, v214, v125, v126
    v_max3_u32 v214, v214, v127, v128
    v_max3_u32 v214, v214, v129, v130
    v_max3_u32 v214, v214, v131, v132
    v_max3_u32 v214, v214, v133, v134
    v_max3_u32 v214, v214, v135, v136
    v_max3_u32 v214, v214, v137, v138
    v_max3_u32 v214, v214, v139, v140
    v_max3_u32 v214, v214, v141, v142
    v_max3_u32 v214, v214, v143, v144
    v_max3_u32 v214, v214, v145, v146
    v_max3_u32 v214, v214, v147, v148
    v_max3_u32 v214, v214, v149, v150
    v_max3_u32 v214, v214, v151, v152
    v_max3_u32 v214, v214, v153, v154
    v_max3_u32 v214, v214, v155, v156
    v_max3_u32 v214, v214, v157, v158
    v_max3_u32 v214, v214, v159, v160
    v_max3_u32 v214, v214, v161, v162
    v_max3_u32 v214, v214, v163, v164
    v_max3_u32 v214, v214, v165, v166
    v_max3_u32 v214, v214, v167, v168
    v_max3_u32 v214, v214, v169, v170
    v_max3_u32 v214, v214, v171, v172
    v_max3_u32 v214, v214, v173, v174
    v_max_u32 v214, v214, v175
    v_cmp_eq_u32 vcc, -1, v214
    s_nop 0
    s_cmp_eq_u64 vcc, 0
    s_cbranch_scc1 L_og_d
    s_cmp_lt_u32 s82, 65536
    s_cbranch_scc1 L_og
L_og_d:
    v_cvt_pk_bf16_f32 v212, v208, v209
    v_cvt_pk_bf16_f32 v213, v210, v211
    ds_write_b64 v9, v[212:213]
    s_mov_b64 exec, s[74:75]
    ds_read_b128 v[176:179], v8 offset:0
    ds_read_b128 v[180:183], v8 offset:64
    ds_read_b128 v[184:187], v8 offset:128
    ds_read_b128 v[188:191], v8 offset:192
    s_mov_b64 exec, -1
    s_waitcnt lgkmcnt(3)
    v_mfma_f32_16x16x32_bf16 v[192:195], v[176:179], v[16:19], v[192:195]
    v_mfma_f32_16x16x32_bf16 v[196:199], v[176:179], v[20:23], v[196:199]
    v_mfma_f32_16x16x32_bf16 v[200:203], v[176:179], v[24:27], v[200:203]
    v_mfma_f32_16x16x32_bf16 v[204:207], v[176:179], v[28:31], v[204:207]
    s_waitcnt lgkmcnt(2)
    v_mfma_f32_16x16x32_bf16 v[192:195], v[180:183], v[32:35], v[192:195]
    v_mfma_f32_16x16x32_bf16 v[196:199], v[180:183], v[36:39], v[196:199]
    v_mfma_f32_16x16x32_bf16 v[200:203], v[180:183], v[40:43], v[200:203]
    v_mfma_f32_16x16x32_bf16 v[204:207], v[180:183], v[44:47], v[204:207]
    s_waitcnt lgkmcnt(1)
    v_mfma_f32_16x16x32_bf16 v[192:195], v[184:187], v[48:51], v[192:195]
    v_mfma_f32_16x16x32_bf16 v[196:199], v[184:187], v[52:55], v[196:199]
    v_mfma_f32_16x16x32_bf16 v[200:203], v[184:187], v[56:59], v[200:203]
    v_mfma_f32_16x16x32_bf16 v[204:207], v[184:187], v[60:63], v[204:207]
    s_waitcnt lgkmcnt(0)
    v_mfma_f32_16x16x32_bf16 v[192:195], v[188:191], v[64:67], v[192:195]
    v_mfma_f32_16x16x32_bf16 v[196:199], v[188:191], v[68:71], v[196:199]
    v_mfma_f32_16x16x32_bf16 v[200:203], v[188:191], v[72:75], v[200:203]
    v_mfma_f32_16x16x32_bf16 v[204:207], v[188:191], v[76:79], v[204:207]
    s_nop 4
    v_min_u32 v208, -2, v192
    v_min_u32 v209, -2, v196
    v_min_u32 v210, -2, v200
    v_min_u32 v211, -2, v204
    v_min_u32 v212, -2, v193
    v_min_u32 v213, -2, v197
    v_min_u32 v214, -2, v201
    v_min_u32 v215, -2, v205
    v_add_u32 v12, 256, v11
    s_mov_b64 exec, 0xffff
    global_store_dwordx4 v11, v[208:211], s[26:27] sc1
    global_store_dwordx4 v12, v[212:215], s[26:27] sc1
    s_mov_b64 exec, -1
L_w7_end:
    s_endpgm
L_w6:
    s_waitcnt lgkmcnt(0)
    s_barrier
    s_branch L_qk
L_w6b:
    s_cmp_lt_u32 s29, 7
    s_cbranch_scc1 L_w6mid
    s_cmp_ge_u32 s30, 18
    s_cbranch_scc1 L_final
    s_branch L_w6_end
L_w6mid:
    s_mov_b32 s46, 0
L_lw19:
    ds_read_b32 v6, v1 offset:224
    s_add_u32 s46, s46, 1
    s_waitcnt lgkmcnt(0)
    v_readfirstlane_b32 s47, v6
    s_nop 0
    s_cmp_ge_u32 s47, 1
    s_cbranch_scc1 L_lw19_d
    s_sleep 1
    s_cmp_lt_u32 s46, 0x400000
    s_cbranch_scc1 L_lw19
L_lw19_d:
    s_sub_u32 s36, s47, 1
    s_cmp_ge_u32 s36, 28
    s_cbranch_scc1 L_w6_end
    s_mul_i32 s67, s36, 37
    s_lshr_b32 s67, s67, 8
    s_mul_i32 s68, s67, 7
    s_sub_u32 s68, s36, s68
    s_lshl_b32 s69, s29, 2
    s_add_u32 s69, s69, s67
    v_and_b32 v3, 15, v0
    v_lshrrev_b32 v4, 4, v0
    v_lshlrev_b32 v5, 10, v4
    v_lshl_add_u32 v5, v3, 3, v5
    s_mov_b32 s46, 0
L_lw20:
    ds_read_b32 v6, v1 offset:88
    s_add_u32 s46, s46, 1
    s_waitcnt lgkmcnt(0)
    v_readfirstlane_b32 s47, v6
    s_nop 0
    s_cmp_ge_u32 s47, 1
    s_cbranch_scc1 L_lw20_d
    s_sleep 1
    s_cmp_lt_u32 s46, 0x400000
    s_cbranch_scc1 L_lw20
L_lw20_d:
    s_lshl_b32 s36, s29, 2
    s_add_u32 s36, s36, s67
    s_lshl_b32 s36, s36, 12
    s_add_u32 s36, s36, 196608
    v_lshrrev_b32 v6, 5, v0
    v_lshlrev_b32 v6, 8, v6
    v_and_b32 v7, 31, v0
    v_lshl_add_u32 v6, v7, 3, v6
    v_add_u32 v6, s36, v6
    s_mov_b32 s82, 0
L_gu:
    global_load_dwordx2 v[64:65], v6, s[26:27] offset:0 sc1
    global_load_dwordx2 v[66:67], v6, s[26:27] offset:512 sc1
    global_load_dwordx2 v[68:69], v6, s[26:27] offset:1024 sc1
    global_load_dwordx2 v[70:71], v6, s[26:27] offset:1536 sc1
    global_load_dwordx2 v[72:73], v6, s[26:27] offset:2048 sc1
    global_load_dwordx2 v[74:75], v6, s[26:27] offset:2560 sc1
    global_load_dwordx2 v[76:77], v6, s[26:27] offset:3072 sc1
    global_load_dwordx2 v[78:79], v6, s[26:27] offset:3584 sc1
    s_add_u32 s82, s82, 1
    s_waitcnt vmcnt(0)
    v_max3_u32 v8, v64, v65, v66
    v_max3_u32 v8, v8, v67, v68
    v_max3_u32 v8, v8, v69, v70
    v_max3_u32 v8, v8, v71, v72
    v_max3_u32 v8, v8, v73, v74
    v_max3_u32 v8, v8, v75, v76
    v_max3_u32 v8, v8, v77, v78
    v_max_u32 v8, v8, v79
    v_cmp_eq_u32 vcc, -1, v8
    s_nop 0
    s_cmp_eq_u64 vcc, 0
    s_cbranch_scc1 L_gu_d
    s_sleep 2
    s_cmp_lt_u32 s82, 65536
    s_cbranch_scc1 L_gu
L_gu_d:
    v_add_f32 v64, v64, v66
    v_add_f32 v68, v68, v70
    v_add_f32 v64, v64, v68
    v_add_f32 v65, v65, v67
    v_add_f32 v69, v69, v71
    v_add_f32 v65, v65, v69
    v_add_f32 v72, v72, v74
    v_add_f32 v76, v76, v78
    v_add_f32 v72, v72, v76
    v_add_f32 v73, v73, v75
    v_add_f32 v77, v77, v79
    v_add_f32 v73, v73, v77
    v_cvt_pk_bf16_f32 v8, v64, v65
    v_cvt_pk_bf16_f32 v9, v72, v73
    v_lshlrev_b32 v10, 16, v8
    v_and_b32 v11, 0xffff0000, v8
    v_lshlrev_b32 v12, 16, v9
    v_and_b32 v13, 0xffff0000, v9
    v_mul_f32 v10, v10, v12
    v_mul_f32 v11, v11, v13
    v_cvt_pk_bf16_f32 v10, v10, v11
    v_lshrrev_b32 v11, 5, v0
    v_lshlrev_b32 v11, 7, v11
    v_lshl_add_u32 v11, v7, 2, v11
    v_add_u32 v11, 135168, v11
    ds_write_b32 v11, v10
    v_lshlrev_b32 v12, 7, v3
    v_lshl_add_u32 v12, v4, 4, v12
    v_add_u32 v12, 135168, v12
    v_mov_b32 v96, 0
    v_mov_b32 v97, 0
    v_mov_b32 v98, 0
    v_mov_b32 v99, 0
    v_mov_b32 v100, 0
    v_mov_b32 v101, 0
    v_mov_b32 v102, 0
    v_mov_b32 v103, 0
    v_mov_b32 v112, 0
    v_mov_b32 v113, 0
    v_mov_b32 v114, 0
    v_mov_b32 v115, 0
    v_mov_b32 v116, 0
    v_mov_b32 v117, 0
    v_mov_b32 v118, 0
    v_mov_b32 v119, 0
    v_mov_b32 v120, 0
    v_mov_b32 v121, 0
    v_mov_b32 v122, 0
    v_mov_b32 v123, 0
    v_mov_b32 v124, 0
    v_mov_b32 v125, 0
    v_mov_b32 v126, 0
    v_mov_b32 v127, 0
    v_cmp_gt_u32 vcc, 2, v3
    s_nop 0
    s_mov_b64 exec, vcc
    ds_read_b128 v[96:99], v12 offset:0
    ds_read_b128 v[100:103], v12 offset:64
    s_mov_b64 exec, -1
    s_mul_i32 s36, s68, 28
    s_add_u32 s36, s36, s69
    s_lshl_b32 s36, s36, 9
    s_add_u32 s36, s36, 1015808
    v_lshlrev_b32 v14, 4, v3
    v_add_u32 v14, s36, v14
    s_waitcnt lgkmcnt(0)
    s_mov_b32 s46, 0
L_lw21:
    ds_read_b32 v6, v1 offset:124
    s_add_u32 s46, s46, 1
    s_waitcnt lgkmcnt(0)
    v_readfirstlane_b32 s47, v6
    s_nop 0
    s_cmp_ge_u32 s47, 1
    s_cbranch_scc1 L_lw21_d
    s_sleep 1
    s_cmp_lt_u32 s46, 0x400000
    s_cbranch_scc1 L_lw21
L_lw21_d:
    ds_read_b64 v[32:33], v5 offset:16384
    ds_read_b64 v[34:35], v5 offset:16512
    ds_read_b64 v[36:37], v5 offset:16640
    ds_read_b64 v[38:39], v5 offset:16768
    ds_read_b64 v[40:41], v5 offset:16896
    ds_read_b64 v[42:43], v5 offset:17024
    ds_read_b64 v[44:45], v5 offset:17152
    ds_read_b64 v[46:47], v5 offset:17280
    ds_read_b64 v[48:49], v5 offset:20480
    ds_read_b64 v[50:51], v5 offset:20608
    ds_read_b64 v[52:53], v5 offset:20736
    ds_read_b64 v[54:55], v5 offset:20864
    ds_read_b64 v[56:57], v5 offset:20992
    ds_read_b64 v[58:59], v5 offset:21120
    ds_read_b64 v[60:61], v5 offset:21248
    ds_read_b64 v[62:63], v5 offset:21376
    s_waitcnt lgkmcnt(8)
    v_perm_b32 v16, v34, v32, s33
    v_perm_b32 v20, v34, v32, s34
    v_perm_b32 v24, v35, v33, s33
    v_perm_b32 v28, v35, v33, s34
    v_perm_b32 v17, v38, v36, s33
    v_perm_b32 v21, v38, v36, s34
    v_perm_b32 v25, v39, v37, s33
    v_perm_b32 v29, v39, v37, s34
    v_perm_b32 v18, v42, v40, s33
    v_perm_b32 v22, v42, v40, s34
    v_perm_b32 v26, v43, v41, s33
    v_perm_b32 v30, v43, v41, s34
    v_perm_b32 v19, v46, v44, s33
    v_perm_b32 v23, v46, v44, s34
    v_perm_b32 v27, v47, v45, s33
    v_perm_b32 v31, v47, v45, s34
    s_waitcnt lgkmcnt(0)
    v_perm_b32 v32, v50, v48, s33
    v_perm_b32 v36, v50, v48, s34
    v_perm_b32 v40, v51, v49, s33
    v_perm_b32 v44, v51, v49, s34
    v_perm_b32 v33, v54, v52, s33
    v_perm_b32 v37, v54, v52, s34
    v_perm_b32 v41, v55, v53, s33
    v_perm_b32 v45, v55, v53, s34
    v_perm_b32 v34, v58, v56, s33
    v_perm_b32 v38, v58, v56, s34
    v_perm_b32 v42, v59, v57, s33
    v_perm_b32 v46, v59, v57, s34
    v_perm_b32 v35, v62, v60, s33
    v_perm_b32 v39, v62, v60, s34
    v_perm_b32 v43, v63, v61, s33
    v_perm_b32 v47, v63, v61, s34
    s_waitcnt lgkmcnt(0)
    v_mfma_f32_16x16x32_bf16 v[112:115], v[96:99], v[16:19], v[112:115]
    v_mfma_f32_16x16x32_bf16 v[116:119], v[96:99], v[20:23], v[116:119]
    v_mfma_f32_16x16x32_bf16 v[120:123], v[96:99], v[24:27], v[120:123]
    v_mfma_f32_16x16x32_bf16 v[124:127], v[96:99], v[28:31], v[124:127]
    v_mfma_f32_16x16x32_bf16 v[112:115], v[100:103], v[32:35], v[112:115]
    v_mfma_f32_16x16x32_bf16 v[116:119], v[100:103], v[36:39], v[116:119]
    v_mfma_f32_16x16x32_bf16 v[120:123], v[100:103], v[40:43], v[120:123]
    v_mfma_f32_16x16x32_bf16 v[124:127], v[100:103], v[44:47], v[124:127]
    s_nop 4
    v_min_u32 v128, -2, v112
    v_min_u32 v129, -2, v116
    v_min_u32 v130, -2, v120
    v_min_u32 v131, -2, v124
    v_min_u32 v132, -2, v113
    v_min_u32 v133, -2, v117
    v_min_u32 v134, -2, v121
    v_min_u32 v135, -2, v125
    v_add_u32 v15, 256, v14
    s_mov_b64 exec, 0xffff
    global_store_dwordx4 v14, v[128:131], s[26:27] sc1
    global_store_dwordx4 v15, v[132:135], s[26:27] sc1
    s_mov_b64 exec, -1
L_w6_end:
    s_endpgm
L_final:
    s_sub_u32 s67, s30, 18
    s_lshr_b32 s70, s67, 1
    s_and_b32 s67, s67, 1
    s_mov_b32 s46, 0
L_lw22:
    ds_read_b32 v6, v1 offset:68
    s_add_u32 s46, s46, 1
    s_waitcnt lgkmcnt(0)
    v_readfirstlane_b32 s47, v6
    s_nop 0
    s_cmp_ge_u32 s47, 1
    s_cbranch_scc1 L_lw22_d
    s_sleep 1
    s_cmp_lt_u32 s46, 0x400000
    s_cbranch_scc1 L_lw22
L_lw22_d:
    ds_read_b64 v[8:9], v1 offset:128
    s_mov_b32 s46, 0
L_lw23:
    ds_read_b32 v7, v1 offset:116
    s_add_u32 s46, s46, 1
    s_waitcnt lgkmcnt(0)
    v_readfirstlane_b32 s47, v7
    s_nop 0
    s_cmp_ge_u32 s47, 4
    s_cbranch_scc1 L_lw23_d
    s_sleep 1
    s_cmp_lt_u32 s46, 0x400000
    s_cbranch_scc1 L_lw23
L_lw23_d:
    v_add_u32 v6, 0, v0
    v_lshlrev_b32 v6, 7, v6
    v_add_u32 v6, 4096, v6
    s_mov_b32 s82, 0
L_pff0:
    s_add_u32 s82, s82, 1
    global_load_dwordx2 v[10:11], v6, s[26:27] sc1
L_pff0_t:
    s_waitcnt vmcnt(0)
    v_and_b32 v12, -16, v10
    v_xor_b32 v12, v12, v8
    v_xor_b32 v11, v11, v9
    v_or_b32 v12, v12, v11
    v_cmp_ne_u32 vcc, 0, v12
    s_nop 0
    s_cmp_eq_u64 vcc, 0
    s_cbranch_scc1 L_pff0_d
    s_sleep 2
    s_cmp_lt_u32 s82, 65536
    s_cbranch_scc1 L_pff0
L_pff0_d:
    v_add_u32 v6, 64, v0
    v_lshlrev_b32 v6, 7, v6
    v_add_u32 v6, 4096, v6
    s_mov_b32 s82, 0
L_pff1:
    s_add_u32 s82, s82, 1
    global_load_dwordx2 v[10:11], v6, s[26:27] sc1
L_pff1_t:
    s_waitcnt vmcnt(0)
    v_and_b32 v12, -16, v10
    v_xor_b32 v12, v12, v8
    v_xor_b32 v11, v11, v9
    v_or_b32 v12, v12, v11
    v_cmp_ne_u32 vcc, 0, v12
    s_nop 0
    s_cmp_eq_u64 vcc, 0
    s_cbranch_scc1 L_pff1_d
    s_sleep 2
    s_cmp_lt_u32 s82, 65536
    s_cbranch_scc1 L_pff1
L_pff1_d:
    v_add_u32 v6, 128, v0
    v_lshlrev_b32 v6, 7, v6
    v_add_u32 v6, 4096, v6
    s_mov_b32 s82, 0
L_pff2:
    s_add_u32 s82, s82, 1
    global_load_dwordx2 v[10:11], v6, s[26:27] sc1
L_pff2_t:
    s_waitcnt vmcnt(0)
    v_and_b32 v12, -16, v10
    v_xor_b32 v12, v12, v8
    v_xor_b32 v11, v11, v9
    v_or_b32 v12, v12, v11
    v_cmp_ne_u32 vcc, 0, v12
    s_nop 0
    s_cmp_eq_u64 vcc, 0
    s_cbranch_scc1 L_pff2_d
    s_sleep 2
    s_cmp_lt_u32 s82, 65536
    s_cbranch_scc1 L_pff2
L_pff2_d:
    v_add_u32 v6, 192, v0
    v_lshlrev_b32 v6, 7, v6
    v_add_u32 v6, 4096, v6
    s_mov_b32 s82, 0
L_pff3:
    s_add_u32 s82, s82, 1
    global_load_dwordx2 v[10:11], v6, s[26:27] sc1
L_pff3_t:
    s_waitcnt vmcnt(0)
    v_and_b32 v12, -16, v10
    v_xor_b32 v12, v12, v8
    v_xor_b32 v11, v11, v9
    v_or_b32 v12, v12, v11
    v_cmp_ne_u32 vcc, 0, v12
    s_nop 0
    s_cmp_eq_u64 vcc, 0
    s_cbranch_scc1 L_pff3_d
    s_sleep 2
    s_cmp_lt_u32 s82, 65536
    s_cbranch_scc1 L_pff3
L_pff3_d:
    s_mul_i32 s36, s67, 896
    s_lshl_b32 s37, s70, 7
    s_add_u32 s68, s36, s37
    v_lshlrev_b32 v28, 1, v0
    v_add_u32 v28, s68, v28
    global_load_ushort v21, v28, s[4:5]
    s_mul_i32 s69, s70, 14336
    s_add_u32 s69, s69, 1015808
    s_lshl_b32 s38, s67, 8
    s_add_u32 s38, s38, s69
    v_lshlrev_b32 v24, 2, v0
    v_add_u32 v24, s38, v24
    v_add_u32 v25, 4096, v24
    v_add_u32 v26, 8192, v24
    v_add_u32 v27, 12288, v24
    s_mov_b32 s82, 0
L_fg:
    global_load_dword v32, v24, s[26:27] offset:0 sc1
    global_load_dword v33, v24, s[26:27] offset:512 sc1
    global_load_dword v34, v24, s[26:27] offset:1024 sc1
    global_load_dword v35, v24, s[26:27] offset:1536 sc1
    global_load_dword v36, v24, s[26:27] offset:2048 sc1
    global_load_dword v37, v24, s[26:27] offset:2560 sc1
    global_load_dword v38, v24, s[26:27] offset:3072 sc1
    global_load_dword v39, v24, s[26:27] offset:3584 sc1
    global_load_dword v40, v25, s[26:27] offset:0 sc1
    global_load_dword v41, v25, s[26:27] offset:512 sc1
    global_load_dword v42, v25, s[26:27] offset:1024 sc1
    global_load_dword v43, v25, s[26:27] offset:1536 sc1
    global_load_dword v44, v25, s[26:27] offset:2048 sc1
    global_load_dword v45, v25, s[26:27] offset:2560 sc1
    global_load_dword v46, v25, s[26:27] offset:3072 sc1
    global_load_dword v47, v25, s[26:27] offset:3584 sc1
    global_load_dword v48, v26, s[26:27] offset:0 sc1
    global_load_dword v49, v26, s[26:27] offset:512 sc1
    global_load_dword v50, v26, s[26:27] offset:1024 sc1
    global_load_dword v51, v26, s[26:27] offset:1536 sc1
    global_load_dword v52, v26, s[26:27] offset:2048 sc1
    global_load_dword v53, v26, s[26:27] offset:2560 sc1
    global_load_dword v54, v26, s[26:27] offset:3072 sc1
    global_load_dword v55, v26, s[26:27] offset:3584 sc1
    global_load_dword v56, v27, s[26:27] offset:0 sc1
    global_load_dword v57, v27, s[26:27] offset:512 sc1
    global_load_dword v58, v27, s[26:27] offset:1024 sc1
    global_load_dword v59, v27, s[26:27] offset:1536 sc1
    s_add_u32 s82, s82, 1
    s_waitcnt vmcnt(24)
    v_mov_b32 v16, v32
    v_mov_b32 v17, v33
    v_mov_b32 v18, v34
    v_mov_b32 v19, v35
    s_waitcnt vmcnt(20)
    v_add_f32 v16, v16, v36
    v_add_f32 v17, v17, v37
    v_add_f32 v18, v18, v38
    v_add_f32 v19, v19, v39
    s_waitcnt vmcnt(16)
    v_add_f32 v16, v16, v40
    v_add_f32 v17, v17, v41
    v_add_f32 v18, v18, v42
    v_add_f32 v19, v19, v43
    s_waitcnt vmcnt(12)
    v_add_f32 v16, v16, v44
    v_add_f32 v17, v17, v45
    v_add_f32 v18, v18, v46
    v_add_f32 v19, v19, v47
    s_waitcnt vmcnt(8)
    v_add_f32 v16, v16, v48
    v_add_f32 v17, v17, v49
    v_add_f32 v18, v18, v50
    v_add_f32 v19, v19, v51
    s_waitcnt vmcnt(4)
    v_add_f32 v16, v16, v52
    v_add_f32 v17, v17, v53
    v_add_f32 v18, v18, v54
    v_add_f32 v19, v19, v55
    s_waitcnt vmcnt(0)
    v_add_f32 v16, v16, v56
    v_add_f32 v17, v17, v57
    v_add_f32 v18, v18, v58
    v_add_f32 v19, v19, v59
    v_add_f32 v16, v16, v17
    v_add_f32 v18, v18, v19
    v_add_f32 v16, v16, v18
    v_cmp_u_f32 vcc, v16, v16
    s_nop 0
    s_cmp_eq_u64 vcc, 0
    s_cbranch_scc1 L_fg_d
    v_max3_u32 v7, v32, v33, v34
    v_max3_u32 v7, v7, v35, v36
    v_max3_u32 v7, v7, v37, v38
    v_max3_u32 v7, v7, v39, v40
    v_max3_u32 v7, v7, v41, v42
    v_max3_u32 v7, v7, v43, v44
    v_max3_u32 v7, v7, v45, v46
    v_max3_u32 v7, v7, v47, v48
    v_max3_u32 v7, v7, v49, v50
    v_max3_u32 v7, v7, v51, v52
    v_max3_u32 v7, v7, v53, v54
    v_max3_u32 v7, v7, v55, v56
    v_max3_u32 v7, v7, v57, v58
    v_max_u32 v7, v7, v59
    v_cmp_eq_u32 vcc, -1, v7
    s_nop 0
    s_cmp_eq_u64 vcc, 0
    s_cbranch_scc1 L_fg_d
    s_sleep 2
    s_cmp_lt_u32 s82, 65536
    s_cbranch_scc1 L_fg
L_fg_d:
    v_cvt_pk_bf16_f32 v16, v16, v16
    v_lshlrev_b32 v16, 16, v16
    v_mul_f32 v7, 0xbfb8aa3b, v16
    v_exp_f32 v7, v7
    s_nop 0
    v_add_f32 v7, 1.0, v7
    v_rcp_f32 v8, v7
    s_nop 0
    v_mul_f32 v9, v16, v8
    v_fma_f32 v10, -v9, v7, v16
    v_fma_f32 v11, v10, v8, v9
    v_cmp_u_f32 vcc, v11, v11
    s_nop 1
    v_cndmask_b32 v20, v11, v9, vcc
    v_cvt_pk_bf16_f32 v20, v20, v20
    v_lshlrev_b32 v20, 16, v20
    v_lshlrev_b32 v21, 16, v21
    s_lshl_b32 s69, s70, 14
    s_add_u32 s69, s69, 884736
    s_mov_b32 s46, 0
L_lw24:
    ds_read_b32 v7, v1 offset:96
    s_add_u32 s46, s46, 1
    s_waitcnt lgkmcnt(0)
    v_readfirstlane_b32 s47, v7
    s_nop 0
    s_cmp_ge_u32 s47, 4
    s_cbranch_scc1 L_lw24_d
    s_sleep 1
    s_cmp_lt_u32 s46, 0x400000
    s_cbranch_scc1 L_lw24
L_lw24_d:
    s_lshl_b32 s38, s67, 8
    s_add_u32 s38, s38, s69
    v_lshlrev_b32 v24, 2, v0
    v_add_u32 v24, s38, v24
    v_add_u32 v25, 4096, v24
    v_add_u32 v26, 8192, v24
    v_add_u32 v27, 12288, v24
    s_mov_b32 s82, 0
L_yg:
    global_load_dword v32, v24, s[26:27] offset:0 sc1
    global_load_dword v33, v24, s[26:27] offset:512 sc1
    global_load_dword v34, v24, s[26:27] offset:1024 sc1
    global_load_dword v35, v24, s[26:27] offset:1536 sc1
    global_load_dword v36, v24, s[26:27] offset:2048 sc1
    global_load_dword v37, v24, s[26:27] offset:2560 sc1
    global_load_dword v38, v24, s[26:27] offset:3072 sc1
    global_load_dword v39, v24, s[26:27] offset:3584 sc1
    global_load_dword v40, v25, s[26:27] offset:0 sc1
    global_load_dword v41, v25, s[26:27] offset:512 sc1
    global_load_dword v42, v25, s[26:27] offset:1024 sc1
    global_load_dword v43, v25, s[26:27] offset:1536 sc1
    global_load_dword v44, v25, s[26:27] offset:2048 sc1
    global_load_dword v45, v25, s[26:27] offset:2560 sc1
    global_load_dword v46, v25, s[26:27] offset:3072 sc1
    global_load_dword v47, v25, s[26:27] offset:3584 sc1
    global_load_dword v48, v26, s[26:27] offset:0 sc1
    global_load_dword v49, v26, s[26:27] offset:512 sc1
    global_load_dword v50, v26, s[26:27] offset:1024 sc1
    global_load_dword v51, v26, s[26:27] offset:1536 sc1
    global_load_dword v52, v26, s[26:27] offset:2048 sc1
    global_load_dword v53, v26, s[26:27] offset:2560 sc1
    global_load_dword v54, v26, s[26:27] offset:3072 sc1
    global_load_dword v55, v26, s[26:27] offset:3584 sc1
    global_load_dword v56, v27, s[26:27] offset:0 sc1
    global_load_dword v57, v27, s[26:27] offset:512 sc1
    global_load_dword v58, v27, s[26:27] offset:1024 sc1
    global_load_dword v59, v27, s[26:27] offset:1536 sc1
    global_load_dword v60, v27, s[26:27] offset:2048 sc1
    global_load_dword v61, v27, s[26:27] offset:2560 sc1
    global_load_dword v62, v27, s[26:27] offset:3072 sc1
    global_load_dword v63, v27, s[26:27] offset:3584 sc1
    s_add_u32 s82, s82, 1
    s_waitcnt vmcnt(28)
    v_mov_b32 v16, v32
    v_mov_b32 v17, v33
    v_mov_b32 v18, v34
    v_mov_b32 v19, v35
    s_waitcnt vmcnt(24)
    v_add_f32 v16, v16, v36
    v_add_f32 v17, v17, v37
    v_add_f32 v18, v18, v38
    v_add_f32 v19, v19, v39
    s_waitcnt vmcnt(20)
    v_add_f32 v16, v16, v40
    v_add_f32 v17, v17, v41
    v_add_f32 v18, v18, v42
    v_add_f32 v19, v19, v43
    s_waitcnt vmcnt(16)
    v_add_f32 v16, v16, v44
    v_add_f32 v17, v17, v45
    v_add_f32 v18, v18, v46
    v_add_f32 v19, v19, v47
    s_waitcnt vmcnt(12)
    v_add_f32 v16, v16, v48
    v_add_f32 v17, v17, v49
    v_add_f32 v18, v18, v50
    v_add_f32 v19, v19, v51
    s_waitcnt vmcnt(8)
    v_add_f32 v16, v16, v52
    v_add_f32 v17, v17, v53
    v_add_f32 v18, v18, v54
    v_add_f32 v19, v19, v55
    s_waitcnt vmcnt(4)
    v_add_f32 v16, v16, v56
    v_add_f32 v17, v17, v57
    v_add_f32 v18, v18, v58
    v_add_f32 v19, v19, v59
    s_waitcnt vmcnt(0)
    v_add_f32 v16, v16, v60
    v_add_f32 v17, v17, v61
    v_add_f32 v18, v18, v62
    v_add_f32 v19, v19, v63
    v_add_f32 v16, v16, v17
    v_add_f32 v18, v18, v19
    v_add_f32 v16, v16, v18
    v_cmp_u_f32 vcc, v16, v16
    s_nop 0
    s_cmp_eq_u64 vcc, 0
    s_cbranch_scc1 L_yg_d
    v_max3_u32 v7, v32, v33, v34
    v_max3_u32 v7, v7, v35, v36
    v_max3_u32 v7, v7, v37, v38
    v_max3_u32 v7, v7, v39, v40
    v_max3_u32 v7, v7, v41, v42
    v_max3_u32 v7, v7, v43, v44
    v_max3_u32 v7, v7, v45, v46
    v_max3_u32 v7, v7, v47, v48
    v_max3_u32 v7, v7, v49, v50
    v_max3_u32 v7, v7, v51, v52
    v_max3_u32 v7, v7, v53, v54
    v_max3_u32 v7, v7, v55, v56
    v_max3_u32 v7, v7, v57, v58
    v_max3_u32 v7, v7, v59, v60
    v_max3_u32 v7, v7, v61, v62
    v_max_u32 v7, v7, v63
    v_cmp_eq_u32 vcc, -1, v7
    s_nop 0
    s_cmp_eq_u64 vcc, 0
    s_cbranch_scc1 L_yg_d
    s_cmp_lt_u32 s82, 65536
    s_cbranch_scc1 L_yg
L_yg_d:
    v_cvt_pk_bf16_f32 v16, v16, v16
    v_lshlrev_b32 v16, 16, v16
    v_mul_f32 v16, v16, v20
    v_cvt_pk_bf16_f32 v16, v16, v16
    v_lshlrev_b32 v16, 16, v16
    v_add_f32 v16, v16, v21
    v_cvt_pk_bf16_f32 v16, v16, v16
    global_store_short v28, v16, s[22:23]
    s_or_b32 s36, s70, s67
    s_cmp_lg_u32 s36, 0
    s_cbranch_scc1 L_fin_end
    ds_read_b64 v[8:9], v1 offset:136
    v_mov_b32 v6, 0
    s_waitcnt lgkmcnt(0)
    s_mov_b64 exec, 1
    global_store_dwordx2 v6, v[8:9], s[26:27] sc1
    s_mov_b64 exec, -1
L_fin_end:
L_end:
    s_endpgm
.section .rodata,"a"
.p2align 6
.amdhsa_kernel recurrent_scan__sliding_block_cached__glu_gated_bilinear__decode_kernel
  .amdhsa_next_free_vgpr 256
  .amdhsa_next_free_sgpr 102
  .amdhsa_accum_offset 256
  .amdhsa_group_segment_fixed_size 0
  .amdhsa_kernarg_size 96
  .amdhsa_user_sgpr_count 2
  .amdhsa_user_sgpr_kernarg_segment_ptr 1
  .amdhsa_system_sgpr_workgroup_id_x 1
  .amdhsa_float_denorm_mode_32 3
.end_amdhsa_kernel
```
